```python
import torch

def _softmax(x, axis=-1):
    return torch.softmax(x, dim=axis)
def _gelu(x):
    return torch.nn.functional.gelu(x, approximate="tanh")
def _silu(x):
    return torch.nn.functional.silu(x)
def _sigmoid(x):
    return torch.sigmoid(x)
def _layernorm(x, axis=-1, eps=1e-5):
    m = x.mean(dim=axis, keepdim=True)
    v = x.var(dim=axis, keepdim=True, unbiased=False)
    return (x - m) / torch.sqrt(v + eps)
def _scatter_add(tgt, idx, src, axis=0):
    return tgt.clone().index_add_(axis, idx, src)
def _segment_sum(src, seg, n):
    out = torch.zeros((n,) + src.shape[1:], dtype=src.dtype)
    return out.index_add_(0, seg, src)
def _pad(x, pw):
    flat = tuple(v for pair in reversed(pw) for v in pair)
    return torch.nn.functional.pad(x, flat)

kernel_name = 'standalone__sliding_block_cached__sampling'

def setup_inputs():

    _w = (lambda a: (lambda t: t.to(torch.bfloat16) if t.is_floating_point() else t)(torch.as_tensor(a)))
    B, Sq, D = 16, 1, 576
    Hq, Hkv, Sk, Dh = 32, 16, 4096, 128
    assert Hq % Hkv == 0, (Hq, Hkv)
    return {
        "x": _w((lambda *s: torch.randn(*s, dtype=torch.bfloat16) * 0.8)(B, Sq, D)),
        "k_cache": _w((lambda *s: torch.randn(*s, dtype=torch.bfloat16) * 0.8)(B, Hkv, Sk, Dh)),
        "v_cache": _w((lambda *s: torch.randn(*s, dtype=torch.bfloat16) * 0.05)(B, Hkv, Sk, Dh)),
        "wq": _w((lambda *s: torch.randn(*s, dtype=torch.bfloat16) * 0.8)(D, Hq * Dh) * (D ** -0.5)),
        "wo": _w((lambda *s: torch.randn(*s, dtype=torch.bfloat16) * 0.05)(Hq * Dh, D) * ((Hq * Dh) ** -0.5)),
    }

def reference(x, k_cache, v_cache, wq, wo):
    B, Sq, D = x.shape
    Hq, Dh = 32, 128
    Hkv, Sk = k_cache.shape[1], k_cache.shape[2]
    W = min(4096, max(256, Sk // 4))
    rep = Hq // Hkv
    q = (lambda x, *d: x.permute(*d))((x @ wq).reshape(B, Sq, Hq, Dh), 0, 2, 1, 3)
    k = (lambda x, n, axis: torch.repeat_interleave(x, n, dim=axis))(k_cache[:, :, Sk - W:, :], rep, axis=1)
    v = (lambda x, n, axis: torch.repeat_interleave(x, n, dim=axis))(v_cache[:, :, Sk - W:, :], rep, axis=1)
    scores = torch.einsum("bhqd,bhkd->bhqk", q, k) * (Dh ** -0.5)
    p = _softmax(scores, axis=-1)
    o = torch.einsum("bhqk,bhkd->bhqd", p, v)
    return (lambda x, *d: x.permute(*d))(o, 0, 2, 1, 3).reshape(B, Sq, Hq * Dh) @ wo
```

```asm
; @launch grid=(256,1,1) block=(512,1,1) lds=159488
.amdgcn_target "amdgcn-amd-amdhsa--gfx950"
.text
.globl standalone__sliding_block_cached__sampling_kernel
.p2align 8
.type standalone__sliding_block_cached__sampling_kernel,@function
standalone__sliding_block_cached__sampling_kernel:
  s_cmp_ge_u32 s2, 256
  s_cbranch_scc1 L_end
  s_load_dwordx16 s[4:19], s[0:1], 0
  v_lshrrev_b32 v2, 6, v0
  v_and_b32 v1, 63, v0
  v_readfirstlane_b32 s3, v2
  v_and_b32 v2, 15, v1
  v_lshrrev_b32 v3, 4, v1
  s_getpc_b64 s[58:59]
L_pc0:
  v_lshlrev_b32 v13, 7, v0
  v_min_u32 v13, L_end-L_pc0, v13
  global_load_dword v60, v13, s[58:59]
  v_xor_b32 v13, v2, v3
  v_lshlrev_b32 v13, 4, v13
  v_lshl_or_b32 v4, v3, 8, v13
  s_lshl_b32 s57, s2, 8
  s_add_u32 s57, s57, s3
  s_lshl_b32 s57, s57, 12
  s_add_u32 s57, s57, 0xc0000
  s_mov_b32 s22, 0x39000
  s_mov_b32 s23, 0x20000
  s_mul_i32 s56, s3, 12288
  s_mov_b32 m0, s56
  v_xor_b32 v5, 64, v4
  v_xor_b32 v6, 0x80, v4
  v_xor_b32 v7, 0xc0, v4
  s_waitcnt lgkmcnt(0)
  s_add_u32 s20, s6, s57
  s_addc_u32 s21, s7, 0
  buffer_load_dwordx4 v4, s[20:23], 0 offen offset:0 nt lds
  buffer_load_dwordx4 v5, s[20:23], 0 offen offset:1024 nt lds
  buffer_load_dwordx4 v6, s[20:23], 0 offen offset:2048 nt lds
  buffer_load_dwordx4 v7, s[20:23], 0 offen offset:3072 nt lds
  s_mov_b32 s54, 0x8000
  s_and_b32 s52, s2, 15
  s_lshr_b32 s53, s2, 4
  v_mov_b32 v14, 158336
  v_mov_b32 v16, 0
  v_mov_b32 v17, 0
  v_mov_b32 v18, 0
  v_mov_b32 v19, 0
  s_mov_b64 exec, 1
  ds_write_b128 v14, v[16:19]
  s_mov_b64 exec, -1
  s_waitcnt lgkmcnt(0)
  s_barrier
  s_add_u32 s76, s18, 1835008
  s_addc_u32 s77, s19, 0
  s_load_dwordx2 s[44:45], s[76:77], 0
  v_lshrrev_b32 v52, 1, v1
  v_lshlrev_b32 v52, 13, v52
  v_and_b32 v14, 1, v1
  v_lshl_add_u32 v52, v14, 4, v52
  v_mul_u32_u24 v53, 1152, v2
  v_lshl_add_u32 v53, v3, 4, v53
  s_mov_b32 s46, s53
  s_mov_b32 s31, 0x20000
  s_mov_b32 s32, s4
  s_mov_b32 s33, s5
  s_mov_b32 s34, 18432
  s_mov_b32 s35, 0x20000
  s_add_u32 s24, s8, s57
  s_addc_u32 s25, s9, 0
  s_lshl_b32 s76, s3, 18
  s_add_u32 s72, s76, 4194304
  s_lshl_b32 s78, s3, 6
  s_add_u32 s73, s78, 1024
  s_lshl_b32 s75, s3, 10
  s_add_u32 s75, s75, 131072
  s_add_u32 s74, s75, 16384
  s_mov_b32 s57, 158464
  s_cmp_lt_u32 s3, 2
  s_cselect_b32 s72, s72, 0x7ff00000
  s_cselect_b32 s73, s73, 0x7ff00000
  s_cselect_b32 s74, s74, s57
  s_lshl_b32 s57, s52, 9
  s_lshl_b32 s58, s46, 5
  s_add_u32 s57, s57, s58
  s_sub_u32 s30, 4718592, s57
  s_add_u32 s28, s10, s57
  s_addc_u32 s29, s11, 0
  s_mov_b32 m0, s75
  s_lshl_b32 s76, s3, 18
  buffer_load_dwordx4 v52, s[28:31], s76 offen nt lds
  s_add_u32 m0, s75, 8192
  s_add_u32 s77, s76, 2097152
  buffer_load_dwordx4 v52, s[28:31], s77 offen nt lds
  s_mov_b32 m0, s74
  s_lshl_b32 s78, s3, 6
  buffer_load_dwordx4 v52, s[28:31], s72 offen nt lds
  buffer_load_dwordx4 v[32:35], v53, s[32:35], s78 offen nt
  buffer_load_dwordx4 v[36:39], v53, s[32:35], s78 offen offset:512 nt
  buffer_load_dwordx4 v[40:43], v53, s[32:35], s73 offen nt
  v_lshl_or_b32 v8, v2, 8, v13
  v_add_u32 v8, s56, v8
  v_xor_b32 v9, 64, v8
  v_xor_b32 v10, 0x80, v8
  v_xor_b32 v11, 0xc0, v8
  v_lshlrev_b32 v12, 4, v1
  s_mov_b32 s26, s22
  s_mov_b32 s27, 0x20000
  s_mov_b32 s55, 0
  s_mov_b32 s60, 0x05040100
  s_mov_b32 s61, 0x07060302
  s_mov_b32 s62, 0x3db504f3
  s_mov_b32 s63, 0x3fb8aa3b
  s_getreg_b32 s47, hwreg(HW_REG_XCC_ID)
  s_and_b32 s47, s47, 7
  s_mov_b32 s83, s47
  s_lshl_b32 s58, s52, 8
  s_lshl_b32 s59, s3, 5
  s_add_u32 s58, s58, s59
  s_mul_i32 s58, s58, 1152
  s_lshl_b32 s59, s53, 7
  s_add_u32 s58, s58, s59
  s_cmp_lt_u32 s53, 9
  s_cselect_b32 s38, 35840, 0
  s_cselect_b32 s58, s58, 0
  s_mov_b32 s39, 0x20000
  s_add_u32 s36, s12, s58
  s_addc_u32 s37, s13, 0
  v_lshrrev_b32 v14, 3, v1
  v_mul_u32_u24 v14, 1152, v14
  v_and_b32 v13, 7, v1
  v_lshl_add_u32 v14, v13, 4, v14
  s_lshl_b32 s65, s3, 12
  s_add_u32 s65, s65, 98304
  s_mov_b32 s40, s18
  s_mov_b32 s41, s19
  s_mov_b32 s42, 4194304
  s_mov_b32 s43, 0x20000
  s_mov_b32 s48, s14
  s_mov_b32 s49, s15
  s_mov_b32 s50, 18432
  s_mov_b32 s51, 0x20000
  v_lshrrev_b32 v54, 2, v2
  v_lshl_add_u32 v54, v3, 3, v54
  v_lshlrev_b32 v54, 5, v54
  v_and_b32 v13, 3, v2
  v_lshl_add_u32 v54, v13, 3, v54
  s_lshl_b32 s59, s3, 10
  s_add_u32 s59, s59, 149504
  v_add_u32 v55, s59, v12
  s_cmp_eq_u32 s3, 0
  s_cbranch_scc1 L_w0
  s_cmp_eq_u32 s3, 1
  s_cbranch_scc1 L_w1
L_gen:
  s_add_u32 m0, s56, 4096
  s_nop 0
  buffer_load_dwordx4 v4, s[20:23], s54 offen offset:0 nt lds
  buffer_load_dwordx4 v5, s[20:23], s54 offen offset:1024 nt lds
  s_waitcnt vmcnt(5)
  ds_read_b128 v[128:131], v8 offset:0
  ds_read_b128 v[132:135], v9 offset:0
  ds_read_b128 v[136:139], v10 offset:0
  ds_read_b128 v[140:143], v11 offset:0
  buffer_load_dwordx4 v6, s[20:23], s54 offen offset:2048 nt lds
  buffer_load_dwordx4 v7, s[20:23], s54 offen offset:3072 nt lds
  s_add_u32 s54, s54, 0x8000
  s_add_u32 m0, s56, 8192
  s_nop 0
  buffer_load_dwordx4 v4, s[20:23], s54 offen offset:0 nt lds
  buffer_load_dwordx4 v5, s[20:23], s54 offen offset:1024 nt lds
  s_waitcnt vmcnt(5)
  v_add_u32 v13, s75, v54
  v_add_u32 v15, s74, v54
  ds_read_b64_tr_b16 v[96:97], v13
  ds_read_b64_tr_b16 v[98:99], v13 offset:128
  ds_read_b64_tr_b16 v[100:101], v13 offset:8192
  ds_read_b64_tr_b16 v[102:103], v13 offset:8320
  ds_read_b64_tr_b16 v[104:105], v15
  ds_read_b64_tr_b16 v[106:107], v15 offset:128
  s_waitcnt lgkmcnt(4)
  v_mfma_f32_16x16x32_bf16 v[48:51], v[96:99], v[32:35], 0
  s_waitcnt lgkmcnt(2)
  v_mfma_f32_16x16x32_bf16 v[48:51], v[100:103], v[36:39], v[48:51]
  s_waitcnt lgkmcnt(0)
  s_cmp_ge_u32 s3, 2
  s_cbranch_scc1 3f
  v_mfma_f32_16x16x32_bf16 v[48:51], v[104:107], v[40:43], v[48:51]
3:
  s_add_u32 s44, s44, 1
  s_addc_u32 s84, s45, 0
  s_mul_i32 s45, s44, 0x9e3779b1
  s_xor_b32 s45, s45, s84
  v_mov_b32 v13, 158336
  v_mov_b32 v16, 1
  s_nop 6
  ds_write_b128 v55, v[48:51]
  s_mov_b64 exec, 1
  ds_add_u32 v13, v16 offset:12
  s_mov_b64 exec, -1
  buffer_load_dwordx4 v6, s[20:23], s54 offen offset:2048 nt lds
  s_waitcnt vmcnt(5)
  buffer_load_dwordx4 v7, s[20:23], s54 offen offset:3072 nt lds
  s_add_u32 s54, s54, 0x8000
  s_waitcnt vmcnt(5)
  s_add_u32 m0, s65, 0
  s_mov_b32 s57, 0
  buffer_load_dwordx4 v14, s[36:39], s57 offen nt lds
  s_waitcnt vmcnt(5)
  ds_read_b128 v[144:147], v8 offset:4096
  ds_read_b128 v[148:151], v9 offset:4096
  ds_read_b128 v[152:155], v10 offset:4096
  ds_read_b128 v[156:159], v11 offset:4096
  s_add_u32 m0, s65, 1024
  s_mov_b32 s57, 9216
  buffer_load_dwordx4 v14, s[36:39], s57 offen nt lds
  s_waitcnt vmcnt(5)
  s_add_u32 m0, s65, 2048
  s_mov_b32 s57, 18432
  buffer_load_dwordx4 v14, s[36:39], s57 offen nt lds
  s_waitcnt vmcnt(5)
  s_add_u32 m0, s65, 3072
  s_mov_b32 s57, 27648
  buffer_load_dwordx4 v14, s[36:39], s57 offen nt lds
  s_waitcnt vmcnt(5)
  s_waitcnt lgkmcnt(0)
  s_add_u32 m0, s56, 0
  s_nop 0
  buffer_load_dwordx4 v4, s[20:23], s54 offen offset:0 nt lds
  s_waitcnt vmcnt(5)
  ds_read_b128 v[160:163], v8 offset:8192
  ds_read_b128 v[164:167], v9 offset:8192
  ds_read_b128 v[168:171], v10 offset:8192
  ds_read_b128 v[172:175], v11 offset:8192
  buffer_load_dwordx4 v5, s[20:23], s54 offen offset:1024 nt lds
  s_waitcnt vmcnt(5)
  buffer_load_dwordx4 v6, s[20:23], s54 offen offset:2048 nt lds
  s_waitcnt vmcnt(5)
  buffer_load_dwordx4 v7, s[20:23], s54 offen offset:3072 nt lds
  s_add_u32 s54, s54, 0x8000
  s_waitcnt vmcnt(5)
  s_waitcnt lgkmcnt(0)
  s_add_u32 m0, s56, 4096
  s_nop 0
  buffer_load_dwordx4 v4, s[20:23], s54 offen offset:0 nt lds
  s_waitcnt vmcnt(5)
  buffer_load_dwordx4 v5, s[20:23], s54 offen offset:1024 nt lds
  s_waitcnt vmcnt(5)
  buffer_load_dwordx4 v6, s[20:23], s54 offen offset:2048 nt lds
  s_waitcnt vmcnt(5)
  buffer_load_dwordx4 v7, s[20:23], s54 offen offset:3072 nt lds
  s_add_u32 s54, s54, 0x8000
  s_waitcnt vmcnt(5)
  s_waitcnt lgkmcnt(0)
  s_add_u32 m0, s56, 8192
  s_nop 0
  buffer_load_dwordx4 v4, s[20:23], s54 offen offset:0 nt lds
  s_waitcnt vmcnt(5)
  ds_read_b128 v[176:179], v8 offset:0
  ds_read_b128 v[180:183], v9 offset:0
  ds_read_b128 v[184:187], v10 offset:0
  ds_read_b128 v[188:191], v11 offset:0
  buffer_load_dwordx4 v5, s[20:23], s54 offen offset:1024 nt lds
  s_waitcnt vmcnt(5)
  buffer_load_dwordx4 v6, s[20:23], s54 offen offset:2048 nt lds
  s_waitcnt vmcnt(5)
  buffer_load_dwordx4 v7, s[20:23], s54 offen offset:3072 nt lds
  s_add_u32 s54, s54, 0x8000
  s_waitcnt vmcnt(5)
  s_waitcnt lgkmcnt(0)
  s_add_u32 m0, s56, 0
  s_nop 0
  buffer_load_dwordx4 v4, s[20:23], s54 offen offset:0 nt lds
  s_waitcnt vmcnt(5)
  ds_read_b128 v[192:195], v8 offset:4096
  ds_read_b128 v[196:199], v9 offset:4096
  ds_read_b128 v[200:203], v10 offset:4096
  ds_read_b128 v[204:207], v11 offset:4096
  buffer_load_dwordx4 v5, s[20:23], s54 offen offset:1024 nt lds
  s_waitcnt vmcnt(5)
  buffer_load_dwordx4 v6, s[20:23], s54 offen offset:2048 nt lds
  s_waitcnt vmcnt(5)
  buffer_load_dwordx4 v7, s[20:23], s54 offen offset:3072 nt lds
  s_add_u32 s54, s54, 0x8000
  s_waitcnt vmcnt(5)
  s_waitcnt lgkmcnt(0)
  s_add_u32 m0, s56, 4096
  s_nop 0
  buffer_load_dwordx4 v4, s[20:23], s54 offen offset:0 nt lds
  s_waitcnt vmcnt(5)
  ds_read_b128 v[208:211], v8 offset:8192
  ds_read_b128 v[212:215], v9 offset:8192
  ds_read_b128 v[216:219], v10 offset:8192
  ds_read_b128 v[220:223], v11 offset:8192
  buffer_load_dwordx4 v5, s[20:23], s54 offen offset:1024 nt lds
  s_waitcnt vmcnt(5)
  buffer_load_dwordx4 v6, s[20:23], s54 offen offset:2048 nt lds
  s_waitcnt vmcnt(5)
  buffer_load_dwordx4 v7, s[20:23], s54 offen offset:3072 nt lds
  s_add_u32 s54, s54, 0x8000
  s_waitcnt vmcnt(5)
  buffer_load_dwordx4 v[64:67], v12, s[24:27], s55 offen offset:0 nt
  s_waitcnt vmcnt(5)
  ds_read_b128 v[224:227], v8 offset:0
  ds_read_b128 v[228:231], v9 offset:0
  ds_read_b128 v[232:235], v10 offset:0
  ds_read_b128 v[236:239], v11 offset:0
  buffer_load_dwordx4 v[68:71], v12, s[24:27], s55 offen offset:1024 nt
  s_waitcnt vmcnt(5)
  buffer_load_dwordx4 v[72:75], v12, s[24:27], s55 offen offset:2048 nt
  s_waitcnt vmcnt(5)
  buffer_load_dwordx4 v[76:79], v12, s[24:27], s55 offen offset:3072 nt
  s_add_u32 s55, s55, 0x8000
  s_waitcnt vmcnt(5)
  buffer_load_dwordx4 v[80:83], v12, s[24:27], s55 offen offset:0 nt
  s_waitcnt vmcnt(5)
  ds_read_b128 v[240:243], v8 offset:4096
  ds_read_b128 v[244:247], v9 offset:4096
  ds_read_b128 v[248:251], v10 offset:4096
  ds_read_b128 v[252:255], v11 offset:4096
  buffer_load_dwordx4 v[84:87], v12, s[24:27], s55 offen offset:1024 nt
  s_waitcnt vmcnt(5)
  buffer_load_dwordx4 v[88:91], v12, s[24:27], s55 offen offset:2048 nt
  s_waitcnt vmcnt(5)
  buffer_load_dwordx4 v[92:95], v12, s[24:27], s55 offen offset:3072 nt
  s_add_u32 s55, s55, 0x8000
  s_waitcnt vmcnt(5)
  s_branch L_join
L_w0:
  s_mov_b32 s79, 0
  s_add_u32 m0, s56, 4096
  s_nop 0
  buffer_load_dwordx4 v4, s[20:23], s54 offen offset:0 nt lds
  buffer_load_dwordx4 v5, s[20:23], s54 offen offset:1024 nt lds
  buffer_load_dwordx4 v6, s[20:23], s54 offen offset:2048 nt lds
  s_waitcnt vmcnt(6)
  ds_read_b128 v[128:131], v8 offset:0
  ds_read_b128 v[132:135], v9 offset:0
  ds_read_b128 v[136:139], v10 offset:0
  ds_read_b128 v[140:143], v11 offset:0
  buffer_load_dwordx4 v7, s[20:23], s54 offen offset:3072 nt lds
  s_add_u32 s54, s54, 0x8000
  s_add_u32 m0, s56, 8192
  s_nop 0
  buffer_load_dwordx4 v4, s[20:23], s54 offen offset:0 nt lds
  buffer_load_dwordx4 v5, s[20:23], s54 offen offset:1024 nt lds
  buffer_load_dwordx4 v6, s[20:23], s54 offen offset:2048 nt lds
  s_waitcnt vmcnt(6)
  v_add_u32 v13, s75, v54
  v_add_u32 v15, s74, v54
  ds_read_b64_tr_b16 v[96:97], v13
  ds_read_b64_tr_b16 v[98:99], v13 offset:128
  ds_read_b64_tr_b16 v[100:101], v13 offset:8192
  ds_read_b64_tr_b16 v[102:103], v13 offset:8320
  ds_read_b64_tr_b16 v[104:105], v15
  ds_read_b64_tr_b16 v[106:107], v15 offset:128
  s_waitcnt lgkmcnt(4)
  v_mfma_f32_16x16x32_bf16 v[48:51], v[96:99], v[32:35], 0
  s_waitcnt lgkmcnt(2)
  v_mfma_f32_16x16x32_bf16 v[48:51], v[100:103], v[36:39], v[48:51]
  s_waitcnt lgkmcnt(0)
  s_cmp_ge_u32 s3, 2
  s_cbranch_scc1 3f
  v_mfma_f32_16x16x32_bf16 v[48:51], v[104:107], v[40:43], v[48:51]
3:
  s_add_u32 s44, s44, 1
  s_addc_u32 s84, s45, 0
  s_mul_i32 s45, s44, 0x9e3779b1
  s_xor_b32 s45, s45, s84
  v_mov_b32 v13, 158336
  v_mov_b32 v16, 1
  s_nop 6
  ds_write_b128 v55, v[48:51]
  s_mov_b64 exec, 1
  ds_add_u32 v13, v16 offset:12
  s_mov_b64 exec, -1
  buffer_load_dwordx4 v7, s[20:23], s54 offen offset:3072 nt lds
  s_add_u32 s54, s54, 0x8000
  s_waitcnt vmcnt(6)
  s_add_u32 m0, s65, 0
  s_mov_b32 s57, 0
  buffer_load_dwordx4 v14, s[36:39], s57 offen nt lds
  s_waitcnt vmcnt(6)
  s_add_u32 m0, s65, 1024
  s_mov_b32 s57, 9216
  buffer_load_dwordx4 v14, s[36:39], s57 offen nt lds
  s_waitcnt vmcnt(6)
  ds_read_b128 v[144:147], v8 offset:4096
  ds_read_b128 v[148:151], v9 offset:4096
  ds_read_b128 v[152:155], v10 offset:4096
  ds_read_b128 v[156:159], v11 offset:4096
  s_add_u32 m0, s65, 2048
  s_mov_b32 s57, 18432
  buffer_load_dwordx4 v14, s[36:39], s57 offen nt lds
  s_waitcnt vmcnt(6)
  s_add_u32 m0, s65, 3072
  s_mov_b32 s57, 27648
  buffer_load_dwordx4 v14, s[36:39], s57 offen nt lds
  s_waitcnt vmcnt(6)
  s_cmp_lg_u32 s79, 0
  s_cbranch_scc1 L_pu12
  v_mov_b32 v13, 158336
L_pw12:
  ds_read_b32 v16, v13 offset:12
  s_waitcnt lgkmcnt(0)
  v_readfirstlane_b32 s57, v16
  s_cmp_lt_u32 s57, 8
  s_cbranch_scc1 L_pw12
  s_setprio 3
  v_add_u32 v13, 149504, v12
  ds_read_b128 v[96:99], v13 offset:0
  ds_read_b128 v[100:103], v13 offset:1024
  ds_read_b128 v[104:107], v13 offset:2048
  ds_read_b128 v[108:111], v13 offset:3072
  ds_read_b128 v[112:115], v13 offset:4096
  ds_read_b128 v[116:119], v13 offset:5120
  ds_read_b128 v[120:123], v13 offset:6144
  ds_read_b128 v[124:127], v13 offset:7168
  s_lshl_b32 s57, s52, 14
  s_lshl_b32 s58, s46, 6
  s_add_u32 s57, s57, s58
  v_lshlrev_b32 v13, 10, v2
  v_lshl_add_u32 v13, v3, 4, v13
  s_add_u32 s58, s45, s83
  v_mov_b32 v17, s44
  v_mov_b32 v19, s58
  s_waitcnt lgkmcnt(6)
  v_add_f32 v96, v96, v100
  v_add_f32 v97, v97, v101
  v_add_f32 v98, v98, v102
  v_add_f32 v99, v99, v103
  s_waitcnt lgkmcnt(4)
  v_add_f32 v104, v104, v108
  v_add_f32 v105, v105, v109
  v_add_f32 v106, v106, v110
  v_add_f32 v107, v107, v111
  s_waitcnt lgkmcnt(2)
  v_add_f32 v112, v112, v116
  v_add_f32 v113, v113, v117
  v_add_f32 v114, v114, v118
  v_add_f32 v115, v115, v119
  v_add_f32 v96, v96, v104
  v_add_f32 v97, v97, v105
  v_add_f32 v98, v98, v106
  v_add_f32 v99, v99, v107
  s_waitcnt lgkmcnt(0)
  v_add_f32 v120, v120, v124
  v_add_f32 v121, v121, v125
  v_add_f32 v122, v122, v126
  v_add_f32 v123, v123, v127
  v_add_f32 v112, v112, v120
  v_add_f32 v113, v113, v121
  v_add_f32 v114, v114, v122
  v_add_f32 v115, v115, v123
  v_add_f32 v96, v96, v112
  v_add_f32 v97, v97, v113
  v_add_f32 v98, v98, v114
  v_add_f32 v99, v99, v115
  v_cvt_pk_bf16_f32 v16, v96, v97
  v_cvt_pk_bf16_f32 v18, v98, v99
  buffer_store_dwordx4 v[16:19], v13, s[40:43], s57 offen
  s_setprio 0
  s_mov_b32 s79, 1
L_pu12:
  s_waitcnt lgkmcnt(0)
  s_add_u32 m0, s56, 0
  s_nop 0
  buffer_load_dwordx4 v4, s[20:23], s54 offen offset:0 nt lds
  s_waitcnt vmcnt(6)
  buffer_load_dwordx4 v5, s[20:23], s54 offen offset:1024 nt lds
  s_waitcnt vmcnt(6)
  ds_read_b128 v[160:163], v8 offset:8192
  ds_read_b128 v[164:167], v9 offset:8192
  ds_read_b128 v[168:171], v10 offset:8192
  ds_read_b128 v[172:175], v11 offset:8192
  buffer_load_dwordx4 v6, s[20:23], s54 offen offset:2048 nt lds
  s_waitcnt vmcnt(6)
  buffer_load_dwordx4 v7, s[20:23], s54 offen offset:3072 nt lds
  s_add_u32 s54, s54, 0x8000
  s_waitcnt vmcnt(6)
  s_waitcnt lgkmcnt(0)
  s_add_u32 m0, s56, 4096
  s_nop 0
  buffer_load_dwordx4 v4, s[20:23], s54 offen offset:0 nt lds
  s_waitcnt vmcnt(6)
  buffer_load_dwordx4 v5, s[20:23], s54 offen offset:1024 nt lds
  s_waitcnt vmcnt(6)
  buffer_load_dwordx4 v6, s[20:23], s54 offen offset:2048 nt lds
  s_waitcnt vmcnt(6)
  buffer_load_dwordx4 v7, s[20:23], s54 offen offset:3072 nt lds
  s_add_u32 s54, s54, 0x8000
  s_waitcnt vmcnt(6)
  s_waitcnt lgkmcnt(0)
  s_add_u32 m0, s56, 8192
  s_nop 0
  buffer_load_dwordx4 v4, s[20:23], s54 offen offset:0 nt lds
  s_waitcnt vmcnt(6)
  buffer_load_dwordx4 v5, s[20:23], s54 offen offset:1024 nt lds
  s_waitcnt vmcnt(6)
  ds_read_b128 v[176:179], v8 offset:0
  ds_read_b128 v[180:183], v9 offset:0
  ds_read_b128 v[184:187], v10 offset:0
  ds_read_b128 v[188:191], v11 offset:0
  buffer_load_dwordx4 v6, s[20:23], s54 offen offset:2048 nt lds
  s_waitcnt vmcnt(6)
  buffer_load_dwordx4 v7, s[20:23], s54 offen offset:3072 nt lds
  s_add_u32 s54, s54, 0x8000
  s_waitcnt vmcnt(6)
  s_waitcnt lgkmcnt(0)
  s_add_u32 m0, s56, 0
  s_nop 0
  buffer_load_dwordx4 v4, s[20:23], s54 offen offset:0 nt lds
  s_waitcnt vmcnt(6)
  buffer_load_dwordx4 v5, s[20:23], s54 offen offset:1024 nt lds
  s_waitcnt vmcnt(6)
  ds_read_b128 v[192:195], v8 offset:4096
  ds_read_b128 v[196:199], v9 offset:4096
  ds_read_b128 v[200:203], v10 offset:4096
  ds_read_b128 v[204:207], v11 offset:4096
  buffer_load_dwordx4 v6, s[20:23], s54 offen offset:2048 nt lds
  s_waitcnt vmcnt(6)
  buffer_load_dwordx4 v7, s[20:23], s54 offen offset:3072 nt lds
  s_add_u32 s54, s54, 0x8000
  s_waitcnt vmcnt(6)
  s_waitcnt lgkmcnt(0)
  s_add_u32 m0, s56, 4096
  s_nop 0
  buffer_load_dwordx4 v4, s[20:23], s54 offen offset:0 nt lds
  s_waitcnt vmcnt(6)
  buffer_load_dwordx4 v5, s[20:23], s54 offen offset:1024 nt lds
  s_waitcnt vmcnt(6)
  ds_read_b128 v[208:211], v8 offset:8192
  ds_read_b128 v[212:215], v9 offset:8192
  ds_read_b128 v[216:219], v10 offset:8192
  ds_read_b128 v[220:223], v11 offset:8192
  buffer_load_dwordx4 v6, s[20:23], s54 offen offset:2048 nt lds
  s_waitcnt vmcnt(6)
  buffer_load_dwordx4 v7, s[20:23], s54 offen offset:3072 nt lds
  s_add_u32 s54, s54, 0x8000
  s_waitcnt vmcnt(6)
  buffer_load_dwordx4 v[64:67], v12, s[24:27], s55 offen offset:0 nt
  s_waitcnt vmcnt(6)
  buffer_load_dwordx4 v[68:71], v12, s[24:27], s55 offen offset:1024 nt
  s_waitcnt vmcnt(6)
  ds_read_b128 v[224:227], v8 offset:0
  ds_read_b128 v[228:231], v9 offset:0
  ds_read_b128 v[232:235], v10 offset:0
  ds_read_b128 v[236:239], v11 offset:0
  buffer_load_dwordx4 v[72:75], v12, s[24:27], s55 offen offset:2048 nt
  s_waitcnt vmcnt(6)
  buffer_load_dwordx4 v[76:79], v12, s[24:27], s55 offen offset:3072 nt
  s_add_u32 s55, s55, 0x8000
  s_waitcnt vmcnt(6)
  buffer_load_dwordx4 v[80:83], v12, s[24:27], s55 offen offset:0 nt
  s_waitcnt vmcnt(6)
  buffer_load_dwordx4 v[84:87], v12, s[24:27], s55 offen offset:1024 nt
  s_waitcnt vmcnt(6)
  ds_read_b128 v[240:243], v8 offset:4096
  ds_read_b128 v[244:247], v9 offset:4096
  ds_read_b128 v[248:251], v10 offset:4096
  ds_read_b128 v[252:255], v11 offset:4096
  buffer_load_dwordx4 v[88:91], v12, s[24:27], s55 offen offset:2048 nt
  s_waitcnt vmcnt(6)
  buffer_load_dwordx4 v[92:95], v12, s[24:27], s55 offen offset:3072 nt
  s_add_u32 s55, s55, 0x8000
  s_waitcnt vmcnt(5)
  s_branch L_join
L_w1:
  s_mov_b32 s79, 0
  s_add_u32 m0, s56, 4096
  s_nop 0
  buffer_load_dwordx4 v4, s[20:23], s54 offen offset:0 nt lds
  buffer_load_dwordx4 v5, s[20:23], s54 offen offset:1024 nt lds
  buffer_load_dwordx4 v6, s[20:23], s54 offen offset:2048 nt lds
  s_waitcnt vmcnt(6)
  ds_read_b128 v[128:131], v8 offset:0
  ds_read_b128 v[132:135], v9 offset:0
  ds_read_b128 v[136:139], v10 offset:0
  ds_read_b128 v[140:143], v11 offset:0
  buffer_load_dwordx4 v7, s[20:23], s54 offen offset:3072 nt lds
  s_add_u32 s54, s54, 0x8000
  s_add_u32 m0, s56, 8192
  s_nop 0
  buffer_load_dwordx4 v4, s[20:23], s54 offen offset:0 nt lds
  buffer_load_dwordx4 v5, s[20:23], s54 offen offset:1024 nt lds
  buffer_load_dwordx4 v6, s[20:23], s54 offen offset:2048 nt lds
  s_waitcnt vmcnt(6)
  v_add_u32 v13, s75, v54
  v_add_u32 v15, s74, v54
  ds_read_b64_tr_b16 v[96:97], v13
  ds_read_b64_tr_b16 v[98:99], v13 offset:128
  ds_read_b64_tr_b16 v[100:101], v13 offset:8192
  ds_read_b64_tr_b16 v[102:103], v13 offset:8320
  ds_read_b64_tr_b16 v[104:105], v15
  ds_read_b64_tr_b16 v[106:107], v15 offset:128
  s_waitcnt lgkmcnt(4)
  v_mfma_f32_16x16x32_bf16 v[48:51], v[96:99], v[32:35], 0
  s_waitcnt lgkmcnt(2)
  v_mfma_f32_16x16x32_bf16 v[48:51], v[100:103], v[36:39], v[48:51]
  s_waitcnt lgkmcnt(0)
  s_cmp_ge_u32 s3, 2
  s_cbranch_scc1 3f
  v_mfma_f32_16x16x32_bf16 v[48:51], v[104:107], v[40:43], v[48:51]
3:
  s_add_u32 s44, s44, 1
  s_addc_u32 s84, s45, 0
  s_mul_i32 s45, s44, 0x9e3779b1
  s_xor_b32 s45, s45, s84
  v_mov_b32 v13, 158336
  v_mov_b32 v16, 1
  s_nop 6
  ds_write_b128 v55, v[48:51]
  s_mov_b64 exec, 1
  ds_add_u32 v13, v16 offset:12
  s_mov_b64 exec, -1
  buffer_load_dwordx4 v7, s[20:23], s54 offen offset:3072 nt lds
  s_add_u32 s54, s54, 0x8000
  s_waitcnt vmcnt(6)
  s_add_u32 m0, s65, 0
  s_mov_b32 s57, 0
  buffer_load_dwordx4 v14, s[36:39], s57 offen nt lds
  s_waitcnt vmcnt(6)
  s_add_u32 m0, s65, 1024
  s_mov_b32 s57, 9216
  buffer_load_dwordx4 v14, s[36:39], s57 offen nt lds
  s_waitcnt vmcnt(6)
  ds_read_b128 v[144:147], v8 offset:4096
  ds_read_b128 v[148:151], v9 offset:4096
  ds_read_b128 v[152:155], v10 offset:4096
  ds_read_b128 v[156:159], v11 offset:4096
  s_add_u32 m0, s65, 2048
  s_mov_b32 s57, 18432
  buffer_load_dwordx4 v14, s[36:39], s57 offen nt lds
  s_waitcnt vmcnt(6)
  s_add_u32 m0, s65, 3072
  s_mov_b32 s57, 27648
  buffer_load_dwordx4 v14, s[36:39], s57 offen nt lds
  s_waitcnt vmcnt(6)
  s_waitcnt lgkmcnt(0)
  s_add_u32 m0, s56, 0
  s_nop 0
  buffer_load_dwordx4 v4, s[20:23], s54 offen offset:0 nt lds
  s_waitcnt vmcnt(6)
  s_cmp_lg_u32 s79, 0
  s_cbranch_scc1 L_pi13
  s_lshl_b32 s57, s52, 14
  s_lshl_b32 s58, s53, 10
  s_add_u32 s57, s57, s58
  buffer_load_dwordx4 v[16:19], v12, s[40:43], s57 offen sc1
L_pi13:
  buffer_load_dwordx4 v5, s[20:23], s54 offen offset:1024 nt lds
  s_waitcnt vmcnt(6)
  ds_read_b128 v[160:163], v8 offset:8192
  ds_read_b128 v[164:167], v9 offset:8192
  ds_read_b128 v[168:171], v10 offset:8192
  ds_read_b128 v[172:175], v11 offset:8192
  buffer_load_dwordx4 v6, s[20:23], s54 offen offset:2048 nt lds
  s_waitcnt vmcnt(6)
  s_cmp_lg_u32 s79, 0
  s_cbranch_scc1 L_pc13
  s_waitcnt vmcnt(2)
  v_subrev_u32 v21, s45, v19
  v_xor_b32 v20, s44, v17
  v_lshrrev_b32 v22, 4, v21
  v_or_b32 v20, v20, v22
  v_cmp_ne_u32 vcc, 0, v20
  s_nop 1
  s_cmp_lg_u64 vcc, 0
  s_cbranch_scc1 L_pc13
  v_mov_b32 v17, v18
  v_lshlrev_b32 v13, 3, v1
  v_add_u32 v13, 157696, v13
  ds_write_b64 v13, v[16:17]
  v_cmp_ne_u32 vcc, s47, v21
  s_nop 1
  s_cmp_lg_u64 vcc, 0
  s_cselect_b32 s57, 1, 0
  v_mov_b32 v56, s57
  s_mov_b32 s79, 1
  v_mov_b32 v57, s79
  v_mov_b32 v13, 158336
  s_waitcnt lgkmcnt(0)
  s_mov_b64 exec, 1
  ds_write_b64 v13, v[56:57]
  s_mov_b64 exec, -1
L_pc13:
  buffer_load_dwordx4 v7, s[20:23], s54 offen offset:3072 nt lds
  s_add_u32 s54, s54, 0x8000
  s_waitcnt vmcnt(6)
  s_cmp_lg_u32 s79, 0
  s_cbranch_scc1 L_pi16
  s_lshl_b32 s57, s52, 14
  s_lshl_b32 s58, s53, 10
  s_add_u32 s57, s57, s58
  buffer_load_dwordx4 v[16:19], v12, s[40:43], s57 offen sc1
L_pi16:
  s_waitcnt lgkmcnt(0)
  s_add_u32 m0, s56, 4096
  s_nop 0
  buffer_load_dwordx4 v4, s[20:23], s54 offen offset:0 nt lds
  s_waitcnt vmcnt(6)
  buffer_load_dwordx4 v5, s[20:23], s54 offen offset:1024 nt lds
  s_waitcnt vmcnt(6)
  s_cmp_lg_u32 s79, 0
  s_cbranch_scc1 L_pc16
  s_waitcnt vmcnt(2)
  v_subrev_u32 v21, s45, v19
  v_xor_b32 v20, s44, v17
  v_lshrrev_b32 v22, 4, v21
  v_or_b32 v20, v20, v22
  v_cmp_ne_u32 vcc, 0, v20
  s_nop 1
  s_cmp_lg_u64 vcc, 0
  s_cbranch_scc1 L_pc16
  v_mov_b32 v17, v18
  v_lshlrev_b32 v13, 3, v1
  v_add_u32 v13, 157696, v13
  ds_write_b64 v13, v[16:17]
  v_cmp_ne_u32 vcc, s47, v21
  s_nop 1
  s_cmp_lg_u64 vcc, 0
  s_cselect_b32 s57, 1, 0
  v_mov_b32 v56, s57
  s_mov_b32 s79, 1
  v_mov_b32 v57, s79
  v_mov_b32 v13, 158336
  s_waitcnt lgkmcnt(0)
  s_mov_b64 exec, 1
  ds_write_b64 v13, v[56:57]
  s_mov_b64 exec, -1
L_pc16:
  buffer_load_dwordx4 v6, s[20:23], s54 offen offset:2048 nt lds
  s_waitcnt vmcnt(6)
  s_cmp_lg_u32 s79, 0
  s_cbranch_scc1 L_pi19
  s_lshl_b32 s57, s52, 14
  s_lshl_b32 s58, s53, 10
  s_add_u32 s57, s57, s58
  buffer_load_dwordx4 v[16:19], v12, s[40:43], s57 offen sc1
L_pi19:
  buffer_load_dwordx4 v7, s[20:23], s54 offen offset:3072 nt lds
  s_add_u32 s54, s54, 0x8000
  s_waitcnt vmcnt(6)
  s_waitcnt lgkmcnt(0)
  s_add_u32 m0, s56, 8192
  s_nop 0
  buffer_load_dwordx4 v4, s[20:23], s54 offen offset:0 nt lds
  s_waitcnt vmcnt(6)
  s_cmp_lg_u32 s79, 0
  s_cbranch_scc1 L_pc19
  s_waitcnt vmcnt(2)
  v_subrev_u32 v21, s45, v19
  v_xor_b32 v20, s44, v17
  v_lshrrev_b32 v22, 4, v21
  v_or_b32 v20, v20, v22
  v_cmp_ne_u32 vcc, 0, v20
  s_nop 1
  s_cmp_lg_u64 vcc, 0
  s_cbranch_scc1 L_pc19
  v_mov_b32 v17, v18
  v_lshlrev_b32 v13, 3, v1
  v_add_u32 v13, 157696, v13
  ds_write_b64 v13, v[16:17]
  v_cmp_ne_u32 vcc, s47, v21
  s_nop 1
  s_cmp_lg_u64 vcc, 0
  s_cselect_b32 s57, 1, 0
  v_mov_b32 v56, s57
  s_mov_b32 s79, 1
  v_mov_b32 v57, s79
  v_mov_b32 v13, 158336
  s_waitcnt lgkmcnt(0)
  s_mov_b64 exec, 1
  ds_write_b64 v13, v[56:57]
  s_mov_b64 exec, -1
L_pc19:
  buffer_load_dwordx4 v5, s[20:23], s54 offen offset:1024 nt lds
  s_waitcnt vmcnt(6)
  ds_read_b128 v[176:179], v8 offset:0
  ds_read_b128 v[180:183], v9 offset:0
  ds_read_b128 v[184:187], v10 offset:0
  ds_read_b128 v[188:191], v11 offset:0
  s_cmp_lg_u32 s79, 0
  s_cbranch_scc1 L_pi22
  s_lshl_b32 s57, s52, 14
  s_lshl_b32 s58, s53, 10
  s_add_u32 s57, s57, s58
  buffer_load_dwordx4 v[16:19], v12, s[40:43], s57 offen sc1
L_pi22:
  buffer_load_dwordx4 v6, s[20:23], s54 offen offset:2048 nt lds
  s_waitcnt vmcnt(6)
  buffer_load_dwordx4 v7, s[20:23], s54 offen offset:3072 nt lds
  s_add_u32 s54, s54, 0x8000
  s_waitcnt vmcnt(6)
  s_cmp_lg_u32 s79, 0
  s_cbranch_scc1 L_pc22
  s_waitcnt vmcnt(2)
  v_subrev_u32 v21, s45, v19
  v_xor_b32 v20, s44, v17
  v_lshrrev_b32 v22, 4, v21
  v_or_b32 v20, v20, v22
  v_cmp_ne_u32 vcc, 0, v20
  s_nop 1
  s_cmp_lg_u64 vcc, 0
  s_cbranch_scc1 L_pc22
  v_mov_b32 v17, v18
  v_lshlrev_b32 v13, 3, v1
  v_add_u32 v13, 157696, v13
  ds_write_b64 v13, v[16:17]
  v_cmp_ne_u32 vcc, s47, v21
  s_nop 1
  s_cmp_lg_u64 vcc, 0
  s_cselect_b32 s57, 1, 0
  v_mov_b32 v56, s57
  s_mov_b32 s79, 1
  v_mov_b32 v57, s79
  v_mov_b32 v13, 158336
  s_waitcnt lgkmcnt(0)
  s_mov_b64 exec, 1
  ds_write_b64 v13, v[56:57]
  s_mov_b64 exec, -1
L_pc22:
  s_waitcnt lgkmcnt(0)
  s_add_u32 m0, s56, 0
  s_nop 0
  buffer_load_dwordx4 v4, s[20:23], s54 offen offset:0 nt lds
  s_waitcnt vmcnt(6)
  buffer_load_dwordx4 v5, s[20:23], s54 offen offset:1024 nt lds
  s_waitcnt vmcnt(6)
  ds_read_b128 v[192:195], v8 offset:4096
  ds_read_b128 v[196:199], v9 offset:4096
  ds_read_b128 v[200:203], v10 offset:4096
  ds_read_b128 v[204:207], v11 offset:4096
  s_cmp_lg_u32 s79, 0
  s_cbranch_scc1 L_pi26
  s_lshl_b32 s57, s52, 14
  s_lshl_b32 s58, s53, 10
  s_add_u32 s57, s57, s58
  buffer_load_dwordx4 v[16:19], v12, s[40:43], s57 offen sc1
L_pi26:
  buffer_load_dwordx4 v6, s[20:23], s54 offen offset:2048 nt lds
  s_waitcnt vmcnt(6)
  buffer_load_dwordx4 v7, s[20:23], s54 offen offset:3072 nt lds
  s_add_u32 s54, s54, 0x8000
  s_waitcnt vmcnt(6)
  s_cmp_lg_u32 s79, 0
  s_cbranch_scc1 L_pc26
  s_waitcnt vmcnt(2)
  v_subrev_u32 v21, s45, v19
  v_xor_b32 v20, s44, v17
  v_lshrrev_b32 v22, 4, v21
  v_or_b32 v20, v20, v22
  v_cmp_ne_u32 vcc, 0, v20
  s_nop 1
  s_cmp_lg_u64 vcc, 0
  s_cbranch_scc1 L_pc26
  v_mov_b32 v17, v18
  v_lshlrev_b32 v13, 3, v1
  v_add_u32 v13, 157696, v13
  ds_write_b64 v13, v[16:17]
  v_cmp_ne_u32 vcc, s47, v21
  s_nop 1
  s_cmp_lg_u64 vcc, 0
  s_cselect_b32 s57, 1, 0
  v_mov_b32 v56, s57
  s_mov_b32 s79, 1
  v_mov_b32 v57, s79
  v_mov_b32 v13, 158336
  s_waitcnt lgkmcnt(0)
  s_mov_b64 exec, 1
  ds_write_b64 v13, v[56:57]
  s_mov_b64 exec, -1
L_pc26:
  s_waitcnt lgkmcnt(0)
  s_add_u32 m0, s56, 4096
  s_nop 0
  buffer_load_dwordx4 v4, s[20:23], s54 offen offset:0 nt lds
  s_waitcnt vmcnt(6)
  buffer_load_dwordx4 v5, s[20:23], s54 offen offset:1024 nt lds
  s_waitcnt vmcnt(6)
  ds_read_b128 v[208:211], v8 offset:8192
  ds_read_b128 v[212:215], v9 offset:8192
  ds_read_b128 v[216:219], v10 offset:8192
  ds_read_b128 v[220:223], v11 offset:8192
  buffer_load_dwordx4 v6, s[20:23], s54 offen offset:2048 nt lds
  s_waitcnt vmcnt(6)
  buffer_load_dwordx4 v7, s[20:23], s54 offen offset:3072 nt lds
  s_add_u32 s54, s54, 0x8000
  s_waitcnt vmcnt(6)
  buffer_load_dwordx4 v[64:67], v12, s[24:27], s55 offen offset:0 nt
  s_waitcnt vmcnt(6)
  buffer_load_dwordx4 v[68:71], v12, s[24:27], s55 offen offset:1024 nt
  s_waitcnt vmcnt(6)
  ds_read_b128 v[224:227], v8 offset:0
  ds_read_b128 v[228:231], v9 offset:0
  ds_read_b128 v[232:235], v10 offset:0
  ds_read_b128 v[236:239], v11 offset:0
  buffer_load_dwordx4 v[72:75], v12, s[24:27], s55 offen offset:2048 nt
  s_waitcnt vmcnt(6)
  buffer_load_dwordx4 v[76:79], v12, s[24:27], s55 offen offset:3072 nt
  s_add_u32 s55, s55, 0x8000
  s_waitcnt vmcnt(6)
  buffer_load_dwordx4 v[80:83], v12, s[24:27], s55 offen offset:0 nt
  s_waitcnt vmcnt(6)
  buffer_load_dwordx4 v[84:87], v12, s[24:27], s55 offen offset:1024 nt
  s_waitcnt vmcnt(6)
  ds_read_b128 v[240:243], v8 offset:4096
  ds_read_b128 v[244:247], v9 offset:4096
  ds_read_b128 v[248:251], v10 offset:4096
  ds_read_b128 v[252:255], v11 offset:4096
  buffer_load_dwordx4 v[88:91], v12, s[24:27], s55 offen offset:2048 nt
  s_waitcnt vmcnt(6)
  buffer_load_dwordx4 v[92:95], v12, s[24:27], s55 offen offset:3072 nt
  s_add_u32 s55, s55, 0x8000
  s_waitcnt vmcnt(5)
  s_cmp_lg_u32 s79, 0
  s_cbranch_scc1 L_join
  s_mov_b32 s64, 0
L_qretry:
  s_lshl_b32 s57, s52, 14
  s_lshl_b32 s58, s53, 10
  s_add_u32 s57, s57, s58
  buffer_load_dwordx4 v[16:19], v12, s[40:43], s57 offen sc1
  s_waitcnt vmcnt(0)
  v_subrev_u32 v21, s45, v19
  v_xor_b32 v20, s44, v17
  v_lshrrev_b32 v22, 4, v21
  v_or_b32 v20, v20, v22
  v_cmp_ne_u32 vcc, 0, v20
  s_nop 1
  s_cmp_eq_u64 vcc, 0
  s_cbranch_scc1 L_qok
  s_add_u32 s64, s64, 1
  s_cmp_le_u32 s64, 60
  s_cbranch_scc1 L_qretry
  s_mov_b32 s79, 2
  v_mov_b32 v56, 1
  s_branch L_qflag
L_qok:
  v_mov_b32 v17, v18
  v_lshlrev_b32 v13, 3, v1
  v_add_u32 v13, 157696, v13
  ds_write_b64 v13, v[16:17]
  v_cmp_ne_u32 vcc, s47, v21
  s_nop 1
  s_cmp_lg_u64 vcc, 0
  s_cselect_b32 s57, 1, 0
  v_mov_b32 v56, s57
  s_mov_b32 s79, 1
L_qflag:
  v_mov_b32 v57, s79
  v_mov_b32 v13, 158336
  s_waitcnt lgkmcnt(0)
  s_mov_b64 exec, 1
  ds_write_b64 v13, v[56:57]
  s_mov_b64 exec, -1
L_join:
  v_mov_b32 v58, 158336
  v_and_b32 v13, 1, v1
  v_lshlrev_b32 v13, 8, v13
  v_lshl_add_u32 v13, v3, 4, v13
  v_add_u32 v14, 157696, v13
  s_lshl_b32 s57, s3, 9
  s_add_u32 s57, s57, 139264
  v_add_u32 v59, s57, v13
L_qwait:
  ds_read_b64 v[56:57], v58
  ds_read_b128 v[16:19], v14 offset:0
  ds_read_b128 v[20:23], v14 offset:64
  ds_read_b128 v[24:27], v14 offset:128
  ds_read_b128 v[28:31], v14 offset:192
  s_waitcnt lgkmcnt(4)
  v_readfirstlane_b32 s78, v56
  v_readfirstlane_b32 s79, v57
  s_cmp_eq_u32 s79, 0
  s_cbranch_scc1 L_qwait
  s_cmp_eq_u32 s79, 2
  s_cbranch_scc1 L_fallback
L_qk:
  buffer_load_dwordx4 v[96:99], v12, s[24:27], s55 offen offset:0 nt
  buffer_load_dwordx4 v[100:103], v12, s[24:27], s55 offen offset:1024 nt
  buffer_load_dwordx4 v[104:107], v12, s[24:27], s55 offen offset:2048 nt
  buffer_load_dwordx4 v[108:111], v12, s[24:27], s55 offen offset:3072 nt
  s_add_u32 s55, s55, 0x8000
  buffer_load_dwordx4 v[112:115], v12, s[24:27], s55 offen offset:0 nt
  buffer_load_dwordx4 v[116:119], v12, s[24:27], s55 offen offset:1024 nt
  buffer_load_dwordx4 v[120:123], v12, s[24:27], s55 offen offset:2048 nt
  buffer_load_dwordx4 v[124:127], v12, s[24:27], s55 offen offset:3072 nt
  s_add_u32 s55, s55, 0x8000
  v_mov_b32 v15, v59
  s_lshl_b32 s57, s3, 9
  s_add_u32 s57, s57, 139264
  v_and_b32 v13, 1, v3
  v_lshlrev_b32 v13, 8, v13
  v_and_b32 v14, 3, v2
  v_lshl_add_u32 v13, v14, 4, v13
  v_lshrrev_b32 v14, 2, v2
  v_lshl_add_u32 v13, v14, 1, v13
  v_add_u32 v13, s57, v13
  v_and_b32 v14, 1, v3
  v_cmp_eq_u32 s[76:77], 1, v14
  s_waitcnt lgkmcnt(0)
  v_mfma_f32_16x16x32_bf16 v[32:35], v[16:19], v[128:131], 0
  v_mfma_f32_16x16x32_bf16 v[32:35], v[20:23], v[132:135], v[32:35]
  v_mfma_f32_16x16x32_bf16 v[32:35], v[24:27], v[136:139], v[32:35]
  v_mfma_f32_16x16x32_bf16 v[32:35], v[28:31], v[140:143], v[32:35]
  v_mfma_f32_16x16x32_bf16 v[36:39], v[16:19], v[144:147], 0
  v_mfma_f32_16x16x32_bf16 v[36:39], v[20:23], v[148:151], v[36:39]
  v_mfma_f32_16x16x32_bf16 v[36:39], v[24:27], v[152:155], v[36:39]
  v_mfma_f32_16x16x32_bf16 v[36:39], v[28:31], v[156:159], v[36:39]
  v_mfma_f32_16x16x32_bf16 v[40:43], v[16:19], v[160:163], 0
  v_mfma_f32_16x16x32_bf16 v[40:43], v[20:23], v[164:167], v[40:43]
  v_mfma_f32_16x16x32_bf16 v[40:43], v[24:27], v[168:171], v[40:43]
  v_mfma_f32_16x16x32_bf16 v[40:43], v[28:31], v[172:175], v[40:43]
  v_mfma_f32_16x16x32_bf16 v[44:47], v[16:19], v[176:179], 0
  v_mfma_f32_16x16x32_bf16 v[44:47], v[20:23], v[180:183], v[44:47]
  v_mfma_f32_16x16x32_bf16 v[44:47], v[24:27], v[184:187], v[44:47]
  v_mfma_f32_16x16x32_bf16 v[44:47], v[28:31], v[188:191], v[44:47]
  v_mfma_f32_16x16x32_bf16 v[48:51], v[16:19], v[192:195], 0
  v_mfma_f32_16x16x32_bf16 v[48:51], v[20:23], v[196:199], v[48:51]
  v_mfma_f32_16x16x32_bf16 v[48:51], v[24:27], v[200:203], v[48:51]
  v_mfma_f32_16x16x32_bf16 v[48:51], v[28:31], v[204:207], v[48:51]
  v_mfma_f32_16x16x32_bf16 v[52:55], v[16:19], v[208:211], 0
  v_mfma_f32_16x16x32_bf16 v[52:55], v[20:23], v[212:215], v[52:55]
  v_mfma_f32_16x16x32_bf16 v[52:55], v[24:27], v[216:219], v[52:55]
  v_mfma_f32_16x16x32_bf16 v[52:55], v[28:31], v[220:223], v[52:55]
  v_mfma_f32_16x16x32_bf16 v[56:59], v[16:19], v[224:227], 0
  v_mfma_f32_16x16x32_bf16 v[56:59], v[20:23], v[228:231], v[56:59]
  v_mfma_f32_16x16x32_bf16 v[56:59], v[24:27], v[232:235], v[56:59]
  v_mfma_f32_16x16x32_bf16 v[56:59], v[28:31], v[236:239], v[56:59]
  v_mfma_f32_16x16x32_bf16 v[60:63], v[16:19], v[240:243], 0
  v_mfma_f32_16x16x32_bf16 v[60:63], v[20:23], v[244:247], v[60:63]
  v_mfma_f32_16x16x32_bf16 v[60:63], v[24:27], v[248:251], v[60:63]
  v_mfma_f32_16x16x32_bf16 v[60:63], v[28:31], v[252:255], v[60:63]
  s_nop 7
  v_cvt_pk_bf16_f32 v34, v32, v33
  v_cvt_pk_bf16_f32 v38, v36, v37
  v_cvt_pk_bf16_f32 v42, v40, v41
  v_cvt_pk_bf16_f32 v46, v44, v45
  v_cvt_pk_bf16_f32 v50, v48, v49
  v_cvt_pk_bf16_f32 v54, v52, v53
  v_cvt_pk_bf16_f32 v58, v56, v57
  v_cvt_pk_bf16_f32 v62, v60, v61
  v_lshlrev_b32 v32, 16, v34
  v_and_b32 v33, 0xffff0000, v34
  v_lshlrev_b32 v36, 16, v38
  v_and_b32 v37, 0xffff0000, v38
  v_lshlrev_b32 v40, 16, v42
  v_and_b32 v41, 0xffff0000, v42
  v_lshlrev_b32 v44, 16, v46
  v_and_b32 v45, 0xffff0000, v46
  v_lshlrev_b32 v48, 16, v50
  v_and_b32 v49, 0xffff0000, v50
  v_lshlrev_b32 v52, 16, v54
  v_and_b32 v53, 0xffff0000, v54
  v_lshlrev_b32 v56, 16, v58
  v_and_b32 v57, 0xffff0000, v58
  v_lshlrev_b32 v60, 16, v62
  v_and_b32 v61, 0xffff0000, v62
  v_mul_f32 v32, s62, v32
  v_mul_f32 v33, s62, v33
  v_mul_f32 v36, s62, v36
  v_mul_f32 v37, s62, v37
  v_mul_f32 v40, s62, v40
  v_mul_f32 v41, s62, v41
  v_mul_f32 v44, s62, v44
  v_mul_f32 v45, s62, v45
  v_mul_f32 v48, s62, v48
  v_mul_f32 v49, s62, v49
  v_mul_f32 v52, s62, v52
  v_mul_f32 v53, s62, v53
  v_mul_f32 v56, s62, v56
  v_mul_f32 v57, s62, v57
  v_mul_f32 v60, s62, v60
  v_mul_f32 v61, s62, v61
  v_cvt_pk_bf16_f32 v34, v32, v33
  v_cvt_pk_bf16_f32 v38, v36, v37
  v_cvt_pk_bf16_f32 v42, v40, v41
  v_cvt_pk_bf16_f32 v46, v44, v45
  v_cvt_pk_bf16_f32 v50, v48, v49
  v_cvt_pk_bf16_f32 v54, v52, v53
  v_cvt_pk_bf16_f32 v58, v56, v57
  v_cvt_pk_bf16_f32 v62, v60, v61
  v_lshlrev_b32 v32, 16, v34
  v_and_b32 v33, 0xffff0000, v34
  v_lshlrev_b32 v36, 16, v38
  v_and_b32 v37, 0xffff0000, v38
  v_lshlrev_b32 v40, 16, v42
  v_and_b32 v41, 0xffff0000, v42
  v_lshlrev_b32 v44, 16, v46
  v_and_b32 v45, 0xffff0000, v46
  v_lshlrev_b32 v48, 16, v50
  v_and_b32 v49, 0xffff0000, v50
  v_lshlrev_b32 v52, 16, v54
  v_and_b32 v53, 0xffff0000, v54
  v_lshlrev_b32 v56, 16, v58
  v_and_b32 v57, 0xffff0000, v58
  v_lshlrev_b32 v60, 16, v62
  v_and_b32 v61, 0xffff0000, v62
  v_max3_f32 v16, v32, v36, v40
  v_max3_f32 v17, v44, v48, v52
  v_max3_f32 v18, v33, v37, v41
  v_max3_f32 v19, v45, v49, v53
  v_max3_f32 v16, v16, v56, v60
  v_max3_f32 v18, v18, v57, v61
  v_max_f32 v16, v16, v17
  v_max_f32 v18, v18, v19
  s_nop 0
  v_max_f32_dpp v16, v16, v16 row_ror:8 row_mask:0xf bank_mask:0xf
  v_max_f32_dpp v18, v18, v18 row_ror:8 row_mask:0xf bank_mask:0xf
  s_nop 0
  v_max_f32_dpp v16, v16, v16 row_ror:4 row_mask:0xf bank_mask:0xf
  v_max_f32_dpp v18, v18, v18 row_ror:4 row_mask:0xf bank_mask:0xf
  s_nop 0
  v_max_f32_dpp v16, v16, v16 row_ror:2 row_mask:0xf bank_mask:0xf
  v_max_f32_dpp v18, v18, v18 row_ror:2 row_mask:0xf bank_mask:0xf
  s_nop 0
  v_max_f32_dpp v16, v16, v16 row_ror:1 row_mask:0xf bank_mask:0xf
  v_max_f32_dpp v18, v18, v18 row_ror:1 row_mask:0xf bank_mask:0xf
  v_sub_f32 v32, v32, v16
  v_sub_f32 v33, v33, v18
  v_sub_f32 v36, v36, v16
  v_sub_f32 v37, v37, v18
  v_sub_f32 v40, v40, v16
  v_sub_f32 v41, v41, v18
  v_sub_f32 v44, v44, v16
  v_sub_f32 v45, v45, v18
  v_sub_f32 v48, v48, v16
  v_sub_f32 v49, v49, v18
  v_sub_f32 v52, v52, v16
  v_sub_f32 v53, v53, v18
  v_sub_f32 v56, v56, v16
  v_sub_f32 v57, v57, v18
  v_sub_f32 v60, v60, v16
  v_sub_f32 v61, v61, v18
  v_mul_f32 v32, s63, v32
  v_mul_f32 v33, s63, v33
  v_mul_f32 v36, s63, v36
  v_mul_f32 v37, s63, v37
  v_mul_f32 v40, s63, v40
  v_mul_f32 v41, s63, v41
  v_mul_f32 v44, s63, v44
  v_mul_f32 v45, s63, v45
  v_mul_f32 v48, s63, v48
  v_mul_f32 v49, s63, v49
  v_mul_f32 v52, s63, v52
  v_mul_f32 v53, s63, v53
  v_mul_f32 v56, s63, v56
  v_mul_f32 v57, s63, v57
  v_mul_f32 v60, s63, v60
  v_mul_f32 v61, s63, v61
  v_exp_f32 v32, v32
  v_exp_f32 v33, v33
  v_exp_f32 v36, v36
  v_exp_f32 v37, v37
  v_exp_f32 v40, v40
  v_exp_f32 v41, v41
  v_exp_f32 v44, v44
  v_exp_f32 v45, v45
  v_exp_f32 v48, v48
  v_exp_f32 v49, v49
  v_exp_f32 v52, v52
  v_exp_f32 v53, v53
  v_exp_f32 v56, v56
  v_exp_f32 v57, v57
  v_exp_f32 v60, v60
  v_exp_f32 v61, v61
  v_cndmask_b32 v34, v32, v33, s[76:77]
  v_cndmask_b32 v38, v36, v37, s[76:77]
  v_cndmask_b32 v42, v40, v41, s[76:77]
  v_cndmask_b32 v46, v44, v45, s[76:77]
  v_cndmask_b32 v50, v48, v49, s[76:77]
  v_cndmask_b32 v54, v52, v53, s[76:77]
  v_cndmask_b32 v58, v56, v57, s[76:77]
  v_cndmask_b32 v62, v60, v61, s[76:77]
  v_cvt_pk_bf16_f32 v34, v34, v34
  v_cvt_pk_bf16_f32 v38, v38, v38
  v_cvt_pk_bf16_f32 v42, v42, v42
  v_cvt_pk_bf16_f32 v46, v46, v46
  v_cvt_pk_bf16_f32 v50, v50, v50
  v_cvt_pk_bf16_f32 v54, v54, v54
  v_cvt_pk_bf16_f32 v58, v58, v58
  v_cvt_pk_bf16_f32 v62, v62, v62
  ds_write_b16 v13, v34 offset:0
  ds_write_b16 v13, v38 offset:8
  ds_write_b16 v13, v42 offset:64
  ds_write_b16 v13, v46 offset:72
  ds_write_b16 v13, v50 offset:128
  ds_write_b16 v13, v54 offset:136
  ds_write_b16 v13, v58 offset:192
  ds_write_b16 v13, v62 offset:200
  v_add_f32 v17, v32, v36
  v_add_f32 v20, v40, v44
  v_add_f32 v22, v48, v52
  v_add_f32 v24, v56, v60
  v_add_f32 v19, v33, v37
  v_add_f32 v21, v41, v45
  v_add_f32 v23, v49, v53
  v_add_f32 v25, v57, v61
  v_add_f32 v17, v17, v20
  v_add_f32 v22, v22, v24
  v_add_f32 v19, v19, v21
  v_add_f32 v23, v23, v25
  v_add_f32 v17, v17, v22
  v_add_f32 v19, v19, v23
  s_nop 0
  v_add_f32_dpp v17, v17, v17 row_ror:8 row_mask:0xf bank_mask:0xf
  v_add_f32_dpp v19, v19, v19 row_ror:8 row_mask:0xf bank_mask:0xf
  s_nop 0
  v_add_f32_dpp v17, v17, v17 row_ror:4 row_mask:0xf bank_mask:0xf
  v_add_f32_dpp v19, v19, v19 row_ror:4 row_mask:0xf bank_mask:0xf
  s_nop 0
  v_add_f32_dpp v17, v17, v17 row_ror:2 row_mask:0xf bank_mask:0xf
  v_add_f32_dpp v19, v19, v19 row_ror:2 row_mask:0xf bank_mask:0xf
  s_nop 0
  v_add_f32_dpp v17, v17, v17 row_ror:1 row_mask:0xf bank_mask:0xf
  v_add_f32_dpp v19, v19, v19 row_ror:1 row_mask:0xf bank_mask:0xf
  s_lshl_b32 s57, s3, 4
  s_add_u32 s57, s57, 158208
  v_mov_b32 v14, s57
  v_mov_b32 v240, v16
  v_mov_b32 v241, v18
  v_mov_b32 v246, 158336
  v_mov_b32 v247, 1
  s_mov_b64 exec, 1
  ds_write_b128 v14, v[16:19]
  ds_add_u32 v246, v247 offset:8
  s_mov_b64 exec, -1
  s_waitcnt lgkmcnt(0)
  ds_read_b128 v[16:19], v15 offset:0
  ds_read_b128 v[20:23], v15 offset:64
  ds_read_b128 v[24:27], v15 offset:128
  ds_read_b128 v[28:31], v15 offset:192
  s_waitcnt vmcnt(5)
  s_waitcnt lgkmcnt(0)
  v_perm_b32 v192, v68, v64, s60
  v_perm_b32 v193, v76, v72, s60
  v_perm_b32 v194, v84, v80, s60
  v_perm_b32 v195, v92, v88, s60
  v_perm_b32 v196, v68, v64, s61
  v_perm_b32 v197, v76, v72, s61
  v_perm_b32 v198, v84, v80, s61
  v_perm_b32 v199, v92, v88, s61
  v_mfma_f32_16x16x32_bf16 v[32:35], v[16:19], v[192:195], 0
  v_perm_b32 v200, v69, v65, s60
  v_perm_b32 v201, v77, v73, s60
  v_perm_b32 v202, v85, v81, s60
  v_perm_b32 v203, v93, v89, s60
  v_mfma_f32_16x16x32_bf16 v[36:39], v[16:19], v[196:199], 0
  v_perm_b32 v204, v69, v65, s61
  v_perm_b32 v205, v77, v73, s61
  v_perm_b32 v206, v85, v81, s61
  v_perm_b32 v207, v93, v89, s61
  v_mfma_f32_16x16x32_bf16 v[40:43], v[16:19], v[200:203], 0
  v_perm_b32 v192, v70, v66, s60
  v_perm_b32 v193, v78, v74, s60
  v_perm_b32 v194, v86, v82, s60
  v_perm_b32 v195, v94, v90, s60
  v_mfma_f32_16x16x32_bf16 v[44:47], v[16:19], v[204:207], 0
  v_perm_b32 v196, v70, v66, s61
  v_perm_b32 v197, v78, v74, s61
  v_perm_b32 v198, v86, v82, s61
  v_perm_b32 v199, v94, v90, s61
  v_mfma_f32_16x16x32_bf16 v[48:51], v[16:19], v[192:195], 0
  v_perm_b32 v200, v71, v67, s60
  v_perm_b32 v201, v79, v75, s60
  v_perm_b32 v202, v87, v83, s60
  v_perm_b32 v203, v95, v91, s60
  v_mfma_f32_16x16x32_bf16 v[52:55], v[16:19], v[196:199], 0
  v_perm_b32 v204, v71, v67, s61
  v_perm_b32 v205, v79, v75, s61
  v_perm_b32 v206, v87, v83, s61
  v_perm_b32 v207, v95, v91, s61
  v_mfma_f32_16x16x32_bf16 v[56:59], v[16:19], v[200:203], 0
  s_nop 1
  v_mfma_f32_16x16x32_bf16 v[60:63], v[16:19], v[204:207], 0
  buffer_load_dwordx4 v[128:131], v12, s[24:27], s55 offen offset:0 nt
  s_waitcnt vmcnt(5)
  buffer_load_dwordx4 v[132:135], v12, s[24:27], s55 offen offset:1024 nt
  s_waitcnt vmcnt(5)
  buffer_load_dwordx4 v[136:139], v12, s[24:27], s55 offen offset:2048 nt
  s_waitcnt vmcnt(5)
  buffer_load_dwordx4 v[140:143], v12, s[24:27], s55 offen offset:3072 nt
  s_add_u32 s55, s55, 0x8000
  s_waitcnt vmcnt(5)
  buffer_load_dwordx4 v[144:147], v12, s[24:27], s55 offen offset:0 nt
  s_waitcnt vmcnt(5)
  v_perm_b32 v192, v100, v96, s60
  v_perm_b32 v193, v108, v104, s60
  v_perm_b32 v194, v116, v112, s60
  v_perm_b32 v195, v124, v120, s60
  v_perm_b32 v196, v100, v96, s61
  v_perm_b32 v197, v108, v104, s61
  v_perm_b32 v198, v116, v112, s61
  v_perm_b32 v199, v124, v120, s61
  v_mfma_f32_16x16x32_bf16 v[32:35], v[20:23], v[192:195], v[32:35]
  v_perm_b32 v200, v101, v97, s60
  v_perm_b32 v201, v109, v105, s60
  v_perm_b32 v202, v117, v113, s60
  v_perm_b32 v203, v125, v121, s60
  v_mfma_f32_16x16x32_bf16 v[36:39], v[20:23], v[196:199], v[36:39]
  v_perm_b32 v204, v101, v97, s61
  v_perm_b32 v205, v109, v105, s61
  v_perm_b32 v206, v117, v113, s61
  v_perm_b32 v207, v125, v121, s61
  v_mfma_f32_16x16x32_bf16 v[40:43], v[20:23], v[200:203], v[40:43]
  v_perm_b32 v192, v102, v98, s60
  v_perm_b32 v193, v110, v106, s60
  v_perm_b32 v194, v118, v114, s60
  v_perm_b32 v195, v126, v122, s60
  v_mfma_f32_16x16x32_bf16 v[44:47], v[20:23], v[204:207], v[44:47]
  v_perm_b32 v196, v102, v98, s61
  v_perm_b32 v197, v110, v106, s61
  v_perm_b32 v198, v118, v114, s61
  v_perm_b32 v199, v126, v122, s61
  v_mfma_f32_16x16x32_bf16 v[48:51], v[20:23], v[192:195], v[48:51]
  v_perm_b32 v200, v103, v99, s60
  v_perm_b32 v201, v111, v107, s60
  v_perm_b32 v202, v119, v115, s60
  v_perm_b32 v203, v127, v123, s60
  v_mfma_f32_16x16x32_bf16 v[52:55], v[20:23], v[196:199], v[52:55]
  v_perm_b32 v204, v103, v99, s61
  v_perm_b32 v205, v111, v107, s61
  v_perm_b32 v206, v119, v115, s61
  v_perm_b32 v207, v127, v123, s61
  v_mfma_f32_16x16x32_bf16 v[56:59], v[20:23], v[200:203], v[56:59]
  s_nop 1
  v_mfma_f32_16x16x32_bf16 v[60:63], v[20:23], v[204:207], v[60:63]
  buffer_load_dwordx4 v[148:151], v12, s[24:27], s55 offen offset:1024 nt
  s_waitcnt vmcnt(5)
  buffer_load_dwordx4 v[152:155], v12, s[24:27], s55 offen offset:2048 nt
  s_waitcnt vmcnt(5)
  buffer_load_dwordx4 v[156:159], v12, s[24:27], s55 offen offset:3072 nt
  s_add_u32 s55, s55, 0x8000
  s_waitcnt vmcnt(5)
  buffer_load_dwordx4 v[160:163], v12, s[24:27], s55 offen offset:0 nt
  s_waitcnt vmcnt(5)
  buffer_load_dwordx4 v[164:167], v12, s[24:27], s55 offen offset:1024 nt
  s_waitcnt vmcnt(5)
  buffer_load_dwordx4 v[168:171], v12, s[24:27], s55 offen offset:2048 nt
  s_waitcnt vmcnt(5)
  buffer_load_dwordx4 v[172:175], v12, s[24:27], s55 offen offset:3072 nt
  s_add_u32 s55, s55, 0x8000
  s_waitcnt vmcnt(5)
  buffer_load_dwordx4 v[176:179], v12, s[24:27], s55 offen offset:0 nt
  s_waitcnt vmcnt(5)
  v_perm_b32 v192, v132, v128, s60
  v_perm_b32 v193, v140, v136, s60
  v_perm_b32 v194, v148, v144, s60
  v_perm_b32 v195, v156, v152, s60
  v_perm_b32 v196, v132, v128, s61
  v_perm_b32 v197, v140, v136, s61
  v_perm_b32 v198, v148, v144, s61
  v_perm_b32 v199, v156, v152, s61
  v_mfma_f32_16x16x32_bf16 v[32:35], v[24:27], v[192:195], v[32:35]
  v_perm_b32 v200, v133, v129, s60
  v_perm_b32 v201, v141, v137, s60
  v_perm_b32 v202, v149, v145, s60
  v_perm_b32 v203, v157, v153, s60
  v_mfma_f32_16x16x32_bf16 v[36:39], v[24:27], v[196:199], v[36:39]
  v_perm_b32 v204, v133, v129, s61
  v_perm_b32 v205, v141, v137, s61
  v_perm_b32 v206, v149, v145, s61
  v_perm_b32 v207, v157, v153, s61
  v_mfma_f32_16x16x32_bf16 v[40:43], v[24:27], v[200:203], v[40:43]
  v_perm_b32 v192, v134, v130, s60
  v_perm_b32 v193, v142, v138, s60
  v_perm_b32 v194, v150, v146, s60
  v_perm_b32 v195, v158, v154, s60
  v_mfma_f32_16x16x32_bf16 v[44:47], v[24:27], v[204:207], v[44:47]
  v_perm_b32 v196, v134, v130, s61
  v_perm_b32 v197, v142, v138, s61
  v_perm_b32 v198, v150, v146, s61
  v_perm_b32 v199, v158, v154, s61
  v_mfma_f32_16x16x32_bf16 v[48:51], v[24:27], v[192:195], v[48:51]
  v_perm_b32 v200, v135, v131, s60
  v_perm_b32 v201, v143, v139, s60
  v_perm_b32 v202, v151, v147, s60
  v_perm_b32 v203, v159, v155, s60
  v_mfma_f32_16x16x32_bf16 v[52:55], v[24:27], v[196:199], v[52:55]
  v_perm_b32 v204, v135, v131, s61
  v_perm_b32 v205, v143, v139, s61
  v_perm_b32 v206, v151, v147, s61
  v_perm_b32 v207, v159, v155, s61
  v_mfma_f32_16x16x32_bf16 v[56:59], v[24:27], v[200:203], v[56:59]
  s_nop 1
  v_mfma_f32_16x16x32_bf16 v[60:63], v[24:27], v[204:207], v[60:63]
  buffer_load_dwordx4 v[180:183], v12, s[24:27], s55 offen offset:1024 nt
  s_waitcnt vmcnt(5)
  buffer_load_dwordx4 v[184:187], v12, s[24:27], s55 offen offset:2048 nt
  s_waitcnt vmcnt(5)
  buffer_load_dwordx4 v[188:191], v12, s[24:27], s55 offen offset:3072 nt
  s_add_u32 s55, s55, 0x8000
  v_mov_b32 v14, 158208
L_stwait:
  ds_read_b32 v247, v246 offset:8
  ds_read_b128 v[208:211], v14 offset:0
  ds_read_b128 v[212:215], v14 offset:16
  ds_read_b128 v[216:219], v14 offset:32
  ds_read_b128 v[220:223], v14 offset:48
  ds_read_b128 v[224:227], v14 offset:64
  ds_read_b128 v[228:231], v14 offset:80
  ds_read_b128 v[232:235], v14 offset:96
  ds_read_b128 v[236:239], v14 offset:112
  s_waitcnt lgkmcnt(8)
  v_readfirstlane_b32 s57, v247
  s_cmp_lt_u32 s57, 8
  s_cbranch_scc1 L_stwait
  s_waitcnt lgkmcnt(0)
  v_max3_f32 v244, v208, v212, v216
  v_max3_f32 v244, v244, v220, v224
  v_max3_f32 v244, v244, v228, v232
  v_max_f32 v244, v244, v236
  v_max3_f32 v245, v210, v214, v218
  v_max3_f32 v245, v245, v222, v226
  v_max3_f32 v245, v245, v230, v234
  v_max_f32 v245, v245, v238
  v_sub_f32 v208, v208, v244
  v_sub_f32 v212, v212, v244
  v_sub_f32 v216, v216, v244
  v_sub_f32 v220, v220, v244
  v_sub_f32 v224, v224, v244
  v_sub_f32 v228, v228, v244
  v_sub_f32 v232, v232, v244
  v_sub_f32 v236, v236, v244
  v_sub_f32 v240, v240, v244
  v_sub_f32 v210, v210, v245
  v_sub_f32 v214, v214, v245
  v_sub_f32 v218, v218, v245
  v_sub_f32 v222, v222, v245
  v_sub_f32 v226, v226, v245
  v_sub_f32 v230, v230, v245
  v_sub_f32 v234, v234, v245
  v_sub_f32 v238, v238, v245
  v_sub_f32 v241, v241, v245
  v_mul_f32 v208, s63, v208
  v_mul_f32 v212, s63, v212
  v_mul_f32 v216, s63, v216
  v_mul_f32 v220, s63, v220
  v_mul_f32 v224, s63, v224
  v_mul_f32 v228, s63, v228
  v_mul_f32 v232, s63, v232
  v_mul_f32 v236, s63, v236
  v_mul_f32 v240, s63, v240
  v_mul_f32 v210, s63, v210
  v_mul_f32 v214, s63, v214
  v_mul_f32 v218, s63, v218
  v_mul_f32 v222, s63, v222
  v_mul_f32 v226, s63, v226
  v_mul_f32 v230, s63, v230
  v_mul_f32 v234, s63, v234
  v_mul_f32 v238, s63, v238
  v_mul_f32 v241, s63, v241
  v_exp_f32 v208, v208
  v_exp_f32 v212, v212
  v_exp_f32 v216, v216
  v_exp_f32 v220, v220
  v_exp_f32 v224, v224
  v_exp_f32 v228, v228
  v_exp_f32 v232, v232
  v_exp_f32 v236, v236
  v_exp_f32 v240, v240
  v_exp_f32 v210, v210
  v_exp_f32 v214, v214
  v_exp_f32 v218, v218
  v_exp_f32 v222, v222
  v_exp_f32 v226, v226
  v_exp_f32 v230, v230
  v_exp_f32 v234, v234
  v_exp_f32 v238, v238
  v_exp_f32 v241, v241
  v_mul_f32 v242, v208, v209
  v_mul_f32 v243, v210, v211
  v_fmac_f32 v242, v212, v213
  v_fmac_f32 v243, v214, v215
  v_fmac_f32 v242, v216, v217
  v_fmac_f32 v243, v218, v219
  v_fmac_f32 v242, v220, v221
  v_fmac_f32 v243, v222, v223
  v_fmac_f32 v242, v224, v225
  v_fmac_f32 v243, v226, v227
  v_fmac_f32 v242, v228, v229
  v_fmac_f32 v243, v230, v231
  v_fmac_f32 v242, v232, v233
  v_fmac_f32 v243, v234, v235
  v_fmac_f32 v242, v236, v237
  v_fmac_f32 v243, v238, v239
  v_rcp_f32 v242, v242
  v_rcp_f32 v243, v243
  s_nop 0
  v_mul_f32 v242, v242, v240
  v_mul_f32 v243, v243, v241
  s_lshl_b32 s57, s3, 10
  s_add_u32 s57, s57, 131072
  v_lshlrev_b32 v14, 5, v2
  v_add_u32 v14, s57, v14
  s_waitcnt vmcnt(0)
  v_perm_b32 v192, v164, v160, s60
  v_perm_b32 v193, v172, v168, s60
  v_perm_b32 v194, v180, v176, s60
  v_perm_b32 v195, v188, v184, s60
  v_perm_b32 v196, v164, v160, s61
  v_perm_b32 v197, v172, v168, s61
  v_perm_b32 v198, v180, v176, s61
  v_perm_b32 v199, v188, v184, s61
  v_mfma_f32_16x16x32_bf16 v[32:35], v[28:31], v[192:195], v[32:35]
  v_perm_b32 v200, v165, v161, s60
  v_perm_b32 v201, v173, v169, s60
  v_perm_b32 v202, v181, v177, s60
  v_perm_b32 v203, v189, v185, s60
  v_mfma_f32_16x16x32_bf16 v[36:39], v[28:31], v[196:199], v[36:39]
  v_perm_b32 v204, v165, v161, s61
  v_perm_b32 v205, v173, v169, s61
  v_perm_b32 v206, v181, v177, s61
  v_perm_b32 v207, v189, v185, s61
  v_mfma_f32_16x16x32_bf16 v[40:43], v[28:31], v[200:203], v[40:43]
  v_perm_b32 v192, v166, v162, s60
  v_perm_b32 v193, v174, v170, s60
  v_perm_b32 v194, v182, v178, s60
  v_perm_b32 v195, v190, v186, s60
  v_mfma_f32_16x16x32_bf16 v[44:47], v[28:31], v[204:207], v[44:47]
  v_perm_b32 v196, v166, v162, s61
  v_perm_b32 v197, v174, v170, s61
  v_perm_b32 v198, v182, v178, s61
  v_perm_b32 v199, v190, v186, s61
  v_mfma_f32_16x16x32_bf16 v[48:51], v[28:31], v[192:195], v[48:51]
  v_perm_b32 v200, v167, v163, s60
  v_perm_b32 v201, v175, v171, s60
  v_perm_b32 v202, v183, v179, s60
  v_perm_b32 v203, v191, v187, s60
  v_mfma_f32_16x16x32_bf16 v[52:55], v[28:31], v[196:199], v[52:55]
  v_perm_b32 v204, v167, v163, s61
  v_perm_b32 v205, v175, v171, s61
  v_perm_b32 v206, v183, v179, s61
  v_perm_b32 v207, v191, v187, s61
  v_mfma_f32_16x16x32_bf16 v[56:59], v[28:31], v[200:203], v[56:59]
  s_nop 1
  v_mfma_f32_16x16x32_bf16 v[60:63], v[28:31], v[204:207], v[60:63]
  s_nop 4
  v_mul_f32 v64, v242, v32
  v_mul_f32 v72, v243, v33
  v_mul_f32 v65, v242, v36
  v_mul_f32 v73, v243, v37
  v_mul_f32 v66, v242, v40
  v_mul_f32 v74, v243, v41
  v_mul_f32 v67, v242, v44
  v_mul_f32 v75, v243, v45
  v_mul_f32 v68, v242, v48
  v_mul_f32 v76, v243, v49
  v_mul_f32 v69, v242, v52
  v_mul_f32 v77, v243, v53
  s_nop 3
  v_mul_f32 v70, v242, v56
  v_mul_f32 v78, v243, v57
  v_mul_f32 v71, v242, v60
  v_mul_f32 v79, v243, v61
  s_mov_b64 exec, 0xffff
  ds_write_b128 v14, v[64:67] offset:0
  ds_write_b128 v14, v[68:71] offset:16
  ds_write_b128 v14, v[72:75] offset:512
  ds_write_b128 v14, v[76:79] offset:528
  s_mov_b64 exec, -1
  s_waitcnt lgkmcnt(0)
  s_barrier
  s_cmp_eq_u32 s3, 0
  s_cbranch_scc1 L_reduce
  s_cmp_ge_u32 s53, 9
  s_cbranch_scc1 L_fin
  s_cmp_ge_u32 s3, 4
  s_cbranch_scc1 L_stageA
  s_cmp_eq_u32 s3, 1
  s_cbranch_scc1 L_final
  s_branch L_fin
L_reduce:
  s_setprio 3
  v_add_u32 v14, 131072, v12
  ds_read_b128 v[64:67], v14 offset:0
  ds_read_b128 v[68:71], v14 offset:1024
  ds_read_b128 v[72:75], v14 offset:2048
  ds_read_b128 v[76:79], v14 offset:3072
  ds_read_b128 v[80:83], v14 offset:4096
  ds_read_b128 v[84:87], v14 offset:5120
  ds_read_b128 v[88:91], v14 offset:6144
  ds_read_b128 v[92:95], v14 offset:7168
  s_lshl_b32 s57, s52, 14
  s_lshl_b32 s58, s53, 4
  s_add_u32 s57, s57, s58
  s_add_u32 s57, s57, 1048576
  v_lshrrev_b32 v13, 3, v1
  v_lshlrev_b32 v13, 11, v13
  v_and_b32 v15, 1, v1
  v_lshl_add_u32 v13, v15, 10, v13
  v_bfe_u32 v15, v1, 1, 2
  v_lshl_add_u32 v13, v15, 8, v13
  v_mov_b32 v17, s44
  v_mov_b32 v19, s45
  s_waitcnt lgkmcnt(6)
  v_add_f32 v64, v64, v68
  v_add_f32 v65, v65, v69
  v_add_f32 v66, v66, v70
  v_add_f32 v67, v67, v71
  s_waitcnt lgkmcnt(4)
  v_add_f32 v72, v72, v76
  v_add_f32 v73, v73, v77
  v_add_f32 v74, v74, v78
  v_add_f32 v75, v75, v79
  s_waitcnt lgkmcnt(2)
  v_add_f32 v80, v80, v84
  v_add_f32 v81, v81, v85
  v_add_f32 v82, v82, v86
  v_add_f32 v83, v83, v87
  v_add_f32 v64, v64, v72
  v_add_f32 v65, v65, v73
  v_add_f32 v66, v66, v74
  v_add_f32 v67, v67, v75
  s_waitcnt lgkmcnt(0)
  v_add_f32 v88, v88, v92
  v_add_f32 v89, v89, v93
  v_add_f32 v90, v90, v94
  v_add_f32 v91, v91, v95
  v_add_f32 v80, v80, v88
  v_add_f32 v81, v81, v89
  v_add_f32 v82, v82, v90
  v_add_f32 v83, v83, v91
  v_add_f32 v64, v64, v80
  v_add_f32 v65, v65, v81
  v_add_f32 v66, v66, v82
  v_add_f32 v67, v67, v83
  v_cvt_pk_bf16_f32 v16, v64, v65
  v_cvt_pk_bf16_f32 v18, v66, v67
  s_cmp_eq_u32 s78, 0
  s_cbranch_scc1 L_red_fast
  buffer_store_dwordx4 v[16:19], v13, s[40:43], s57 offen sc1
  s_branch L_fin
L_red_fast:
  buffer_store_dwordx4 v[16:19], v13, s[40:43], s57 offen
  s_branch L_fin
L_stageA:
  s_sub_u32 s59, s3, 4
  s_lshl_b32 s57, s52, 14
  s_lshl_b32 s58, s59, 12
  s_add_u32 s57, s57, s58
  s_add_u32 s57, s57, 1048576
  buffer_load_dwordx4 v[64:67], v12, s[40:43], s57 offen offset:0 sc1
  buffer_load_dwordx4 v[68:71], v12, s[40:43], s57 offen offset:1024 sc1
  buffer_load_dwordx4 v[72:75], v12, s[40:43], s57 offen offset:2048 sc1
  buffer_load_dwordx4 v[76:79], v12, s[40:43], s57 offen offset:3072 sc1
  v_lshrrev_b32 v14, 2, v2
  v_lshl_add_u32 v14, v3, 3, v14
  v_lshlrev_b32 v14, 7, v14
  v_and_b32 v13, 3, v2
  v_lshl_add_u32 v14, v13, 3, v14
  s_lshl_b32 s58, s59, 13
  s_add_u32 s58, s58, 98304
  v_add_u32 v14, s58, v14
  ds_read_b64_tr_b16 v[128:129], v14 offset:0
  ds_read_b64_tr_b16 v[130:131], v14 offset:512
  ds_read_b64_tr_b16 v[132:133], v14 offset:4096
  ds_read_b64_tr_b16 v[134:135], v14 offset:4608
  ds_read_b64_tr_b16 v[136:137], v14 offset:32
  ds_read_b64_tr_b16 v[138:139], v14 offset:544
  ds_read_b64_tr_b16 v[140:141], v14 offset:4128
  ds_read_b64_tr_b16 v[142:143], v14 offset:4640
  ds_read_b64_tr_b16 v[144:145], v14 offset:64
  ds_read_b64_tr_b16 v[146:147], v14 offset:576
  ds_read_b64_tr_b16 v[148:149], v14 offset:4160
  ds_read_b64_tr_b16 v[150:151], v14 offset:4672
  ds_read_b64_tr_b16 v[152:153], v14 offset:96
  ds_read_b64_tr_b16 v[154:155], v14 offset:608
  ds_read_b64_tr_b16 v[156:157], v14 offset:4192
  ds_read_b64_tr_b16 v[158:159], v14 offset:4704
  s_lshl_b32 s58, s53, 2
  s_add_u32 s58, s58, s59
  s_lshl_b32 s58, s58, 4
  s_add_u32 s58, s58, s52
  s_lshl_b32 s58, s58, 10
  s_add_u32 s58, s58, 2097152
  s_mul_i32 s80, s59, 4608
  v_mul_u32_u24 v20, 272, v3
  v_lshl_add_u32 v20, v2, 4, v20
  v_add_u32 v20, s80, v20
  v_mul_u32_u24 v21, 272, v2
  v_lshl_add_u32 v21, v3, 4, v21
  s_lshl_b32 s80, s59, 6
  v_add_u32 v21, s80, v21
  s_mul_i32 s82, s44, 0x85ebca77
  s_lshr_b32 s80, s45, 20
  s_bfe_u32 s81, s45, 0xc0008
  s_add_u32 s82, s82, s84
  s_bfe_u32 s83, s82, 0xc0008
  s_lshr_b32 s82, s82, 20
  v_mov_b32 v22, 0xfff
  s_mov_b32 s64, 0
L_sa_poll:
  s_waitcnt vmcnt(3)
  v_xor_b32 v17, s44, v65
  v_xor_b32 v18, s45, v67
  v_or_b32 v16, v17, v18
  v_mov_b32 v160, v64
  v_mov_b32 v161, v66
  s_waitcnt vmcnt(2)
  v_xor_b32 v17, s44, v69
  v_xor_b32 v18, s45, v71
  v_or3_b32 v16, v16, v17, v18
  v_mov_b32 v162, v68
  v_mov_b32 v163, v70
  s_waitcnt vmcnt(1)
  v_xor_b32 v17, s44, v73
  v_xor_b32 v18, s45, v75
  v_or3_b32 v16, v16, v17, v18
  v_mov_b32 v164, v72
  v_mov_b32 v165, v74
  s_waitcnt vmcnt(0)
  v_xor_b32 v17, s44, v77
  v_xor_b32 v18, s45, v79
  v_or3_b32 v16, v16, v17, v18
  v_mov_b32 v166, v76
  v_mov_b32 v167, v78
  v_cmp_ne_u32 vcc, 0, v16
  s_nop 1
  s_cmp_eq_u64 vcc, 0
  s_cbranch_scc1 L_sa_go
  s_add_u32 s64, s64, 1
  s_cmp_gt_u32 s64, 200000
  s_cbranch_scc1 L_sa_go
  buffer_load_dwordx4 v[64:67], v12, s[40:43], s57 offen offset:0 sc1
  buffer_load_dwordx4 v[68:71], v12, s[40:43], s57 offen offset:1024 sc1
  buffer_load_dwordx4 v[72:75], v12, s[40:43], s57 offen offset:2048 sc1
  buffer_load_dwordx4 v[76:79], v12, s[40:43], s57 offen offset:3072 sc1
  s_branch L_sa_poll
L_sa_go:
  s_waitcnt lgkmcnt(0)
  v_mfma_f32_16x16x32_bf16 v[32:35], v[128:131], v[160:163], 0
  v_mfma_f32_16x16x32_bf16 v[36:39], v[136:139], v[160:163], 0
  v_mfma_f32_16x16x32_bf16 v[40:43], v[144:147], v[160:163], 0
  v_mfma_f32_16x16x32_bf16 v[44:47], v[152:155], v[160:163], 0
  v_mfma_f32_16x16x32_bf16 v[32:35], v[132:135], v[164:167], v[32:35]
  v_mfma_f32_16x16x32_bf16 v[36:39], v[140:143], v[164:167], v[36:39]
  v_mfma_f32_16x16x32_bf16 v[40:43], v[148:151], v[164:167], v[40:43]
  v_mfma_f32_16x16x32_bf16 v[44:47], v[156:159], v[164:167], v[44:47]
  s_nop 4
  ds_write_b128 v20, v[32:35] offset:0
  s_nop 0
  ds_write_b128 v20, v[36:39] offset:1088
  s_nop 0
  ds_write_b128 v20, v[40:43] offset:2176
  s_nop 0
  ds_write_b128 v20, v[44:47] offset:3264
  s_waitcnt lgkmcnt(0)
  s_barrier
  ds_read_b128 v[32:35], v21 offset:0
  ds_read_b128 v[36:39], v21 offset:4608
  ds_read_b128 v[40:43], v21 offset:9216
  ds_read_b128 v[44:47], v21 offset:13824
  s_waitcnt lgkmcnt(2)
  v_add_f32 v32, v32, v36
  v_add_f32 v33, v33, v37
  v_add_f32 v34, v34, v38
  v_add_f32 v35, v35, v39
  s_waitcnt lgkmcnt(0)
  v_add_f32 v40, v40, v44
  v_add_f32 v41, v41, v45
  v_add_f32 v42, v42, v46
  v_add_f32 v43, v43, v47
  v_add_f32 v32, v32, v40
  v_add_f32 v33, v33, v41
  v_add_f32 v34, v34, v42
  v_add_f32 v35, v35, v43
  v_bfi_b32 v32, v22, s80, v32
  v_bfi_b32 v33, v22, s81, v33
  v_bfi_b32 v34, v22, s82, v34
  v_bfi_b32 v35, v22, s83, v35
  buffer_store_dwordx4 v[32:35], v12, s[40:43], s58 offen sc1
  s_branch L_fin
L_final:
  s_mul_i32 s57, s52, 9
  s_add_u32 s57, s57, s53
  s_lshr_b32 s58, s57, 2
  s_lshl_b32 s58, s58, 14
  s_and_b32 s59, s57, 3
  s_lshl_b32 s59, s59, 8
  s_add_u32 s72, s58, s59
  s_add_u32 s72, s72, 2097152
  s_add_u32 s73, s72, 4096
  s_add_u32 s74, s72, 8192
  s_add_u32 s75, s72, 12288
  v_lshlrev_b32 v14, 10, v3
  v_lshl_add_u32 v14, v2, 4, v14
  s_and_b32 s58, s57, 15
  s_mul_i32 s58, s58, 1152
  s_lshr_b32 s59, s57, 4
  s_lshl_b32 s59, s59, 7
  s_add_u32 s58, s58, s59
  v_lshlrev_b32 v15, 3, v2
  s_mul_i32 s82, s44, 0x85ebca77
  s_lshr_b32 s80, s45, 20
  s_bfe_u32 s81, s45, 0xc0008
  s_add_u32 s82, s82, s84
  s_bfe_u32 s83, s82, 0xc0008
  s_lshr_b32 s82, s82, 20
  s_mov_b32 s64, 0
  s_mov_b32 s79, 0xf
  s_barrier
L_fi_poll:
  s_bitcmp0_b32 s79, 0
  s_cbranch_scc1 L_fl0
  buffer_load_dwordx4 v[64:67], v14, s[40:43], s72 offen sc1
L_fl0:
  s_bitcmp0_b32 s79, 1
  s_cbranch_scc1 L_fl1
  buffer_load_dwordx4 v[68:71], v14, s[40:43], s73 offen sc1
L_fl1:
  s_bitcmp0_b32 s79, 2
  s_cbranch_scc1 L_fl2
  buffer_load_dwordx4 v[72:75], v14, s[40:43], s74 offen sc1
L_fl2:
  s_bitcmp0_b32 s79, 3
  s_cbranch_scc1 L_fl3
  buffer_load_dwordx4 v[76:79], v14, s[40:43], s75 offen sc1
L_fl3:
  s_waitcnt vmcnt(0)
  s_bitcmp0_b32 s79, 0
  s_cbranch_scc1 L_fc0
  v_xor_b32 v16, s80, v64
  v_xor_b32 v17, s81, v65
  v_xor_b32 v18, s82, v66
  v_xor_b32 v19, s83, v67
  v_or3_b32 v20, v16, v17, v18
  v_or_b32 v20, v20, v19
  v_and_b32 v20, 0xfff, v20
  v_cmp_ne_u32 vcc, 0, v20
  s_nop 1
  s_cmp_lg_u64 vcc, 0
  s_cbranch_scc1 L_fc0
  v_mov_b32 v64, v16
  v_mov_b32 v65, v17
  v_mov_b32 v66, v18
  v_mov_b32 v67, v19
  s_bitset0_b32 s79, 0
L_fc0:
  s_bitcmp0_b32 s79, 1
  s_cbranch_scc1 L_fc1
  v_xor_b32 v16, s80, v68
  v_xor_b32 v17, s81, v69
  v_xor_b32 v18, s82, v70
  v_xor_b32 v19, s83, v71
  v_or3_b32 v20, v16, v17, v18
  v_or_b32 v20, v20, v19
  v_and_b32 v20, 0xfff, v20
  v_cmp_ne_u32 vcc, 0, v20
  s_nop 1
  s_cmp_lg_u64 vcc, 0
  s_cbranch_scc1 L_fc1
  v_mov_b32 v68, v16
  v_mov_b32 v69, v17
  v_mov_b32 v70, v18
  v_mov_b32 v71, v19
  s_bitset0_b32 s79, 1
L_fc1:
  s_bitcmp0_b32 s79, 2
  s_cbranch_scc1 L_fc2
  v_xor_b32 v16, s80, v72
  v_xor_b32 v17, s81, v73
  v_xor_b32 v18, s82, v74
  v_xor_b32 v19, s83, v75
  v_or3_b32 v20, v16, v17, v18
  v_or_b32 v20, v20, v19
  v_and_b32 v20, 0xfff, v20
  v_cmp_ne_u32 vcc, 0, v20
  s_nop 1
  s_cmp_lg_u64 vcc, 0
  s_cbranch_scc1 L_fc2
  v_mov_b32 v72, v16
  v_mov_b32 v73, v17
  v_mov_b32 v74, v18
  v_mov_b32 v75, v19
  s_bitset0_b32 s79, 2
L_fc2:
  s_bitcmp0_b32 s79, 3
  s_cbranch_scc1 L_fc3
  v_xor_b32 v16, s80, v76
  v_xor_b32 v17, s81, v77
  v_xor_b32 v18, s82, v78
  v_xor_b32 v19, s83, v79
  v_or3_b32 v20, v16, v17, v18
  v_or_b32 v20, v20, v19
  v_and_b32 v20, 0xfff, v20
  v_cmp_ne_u32 vcc, 0, v20
  s_nop 1
  s_cmp_lg_u64 vcc, 0
  s_cbranch_scc1 L_fc3
  v_mov_b32 v76, v16
  v_mov_b32 v77, v17
  v_mov_b32 v78, v18
  v_mov_b32 v79, v19
  s_bitset0_b32 s79, 3
L_fc3:
  s_cmp_eq_u32 s79, 0
  s_cbranch_scc1 L_fi_go
  s_add_u32 s64, s64, 1
  s_cmp_le_u32 s64, 200000
  s_cbranch_scc1 L_fi_poll
L_fi_go:
  v_add_f32 v64, v64, v68
  v_add_f32 v72, v72, v76
  v_add_f32 v65, v65, v69
  v_add_f32 v73, v73, v77
  v_add_f32 v66, v66, v70
  v_add_f32 v74, v74, v78
  v_add_f32 v67, v67, v71
  v_add_f32 v75, v75, v79
  v_add_f32 v20, v64, v72
  v_add_f32 v21, v65, v73
  v_add_f32 v22, v66, v74
  v_add_f32 v23, v67, v75
  v_add_f32 v24, v64, v72
  v_add_f32 v25, v65, v73
  v_add_f32 v26, v66, v74
  v_add_f32 v27, v67, v75
  v_permlane32_swap_b32 v20, v24
  v_permlane32_swap_b32 v21, v25
  v_permlane32_swap_b32 v22, v26
  v_permlane32_swap_b32 v23, v27
  s_nop 0
  v_add_f32 v28, v20, v24
  v_add_f32 v29, v21, v25
  v_add_f32 v30, v22, v26
  v_add_f32 v31, v23, v27
  v_add_f32 v20, v20, v24
  v_add_f32 v21, v21, v25
  v_add_f32 v22, v22, v26
  v_add_f32 v23, v23, v27
  v_permlane16_swap_b32 v28, v20
  v_permlane16_swap_b32 v29, v21
  v_permlane16_swap_b32 v30, v22
  v_permlane16_swap_b32 v31, v23
  s_nop 0
  v_add_f32 v20, v20, v28
  v_add_f32 v21, v21, v29
  v_add_f32 v22, v22, v30
  v_add_f32 v23, v23, v31
  v_cvt_pk_bf16_f32 v16, v20, v21
  v_cvt_pk_bf16_f32 v17, v22, v23
  s_mov_b64 exec, 0xffff
  buffer_store_dwordx2 v[16:17], v15, s[48:51], s58 offen
  s_mov_b64 exec, -1
  s_cmp_lg_u32 s2, 0
  s_cbranch_scc1 L_fin
  v_mov_b32 v20, s44
  v_mov_b32 v21, s84
  v_mov_b32 v13, 0
  s_mov_b32 s57, 1835008
  s_mov_b64 exec, 1
  buffer_store_dwordx2 v[20:21], v13, s[40:43], s57 offen
  s_mov_b64 exec, -1
  s_branch L_fin
L_fallback:
  s_waitcnt lgkmcnt(0)
  s_mov_b32 s46, 0
  s_mov_b32 s83, 15
L_fb_loop:
  s_lshl_b32 s57, s52, 9
  s_lshl_b32 s58, s46, 5
  s_add_u32 s57, s57, s58
  s_sub_u32 s30, 4718592, s57
  s_add_u32 s28, s10, s57
  s_addc_u32 s29, s11, 0
  s_mov_b32 m0, s75
  s_lshl_b32 s76, s3, 18
  buffer_load_dwordx4 v52, s[28:31], s76 offen nt lds
  s_add_u32 m0, s75, 8192
  s_add_u32 s77, s76, 2097152
  buffer_load_dwordx4 v52, s[28:31], s77 offen nt lds
  s_mov_b32 m0, s74
  s_lshl_b32 s78, s3, 6
  buffer_load_dwordx4 v52, s[28:31], s72 offen nt lds
  buffer_load_dwordx4 v[32:35], v53, s[32:35], s78 offen nt
  buffer_load_dwordx4 v[36:39], v53, s[32:35], s78 offen offset:512 nt
  buffer_load_dwordx4 v[40:43], v53, s[32:35], s73 offen nt
  s_waitcnt vmcnt(0)
  v_add_u32 v13, s75, v54
  v_add_u32 v15, s74, v54
  ds_read_b64_tr_b16 v[96:97], v13
  ds_read_b64_tr_b16 v[98:99], v13 offset:128
  ds_read_b64_tr_b16 v[100:101], v13 offset:8192
  ds_read_b64_tr_b16 v[102:103], v13 offset:8320
  ds_read_b64_tr_b16 v[104:105], v15
  ds_read_b64_tr_b16 v[106:107], v15 offset:128
  s_waitcnt lgkmcnt(4)
  v_mfma_f32_16x16x32_bf16 v[48:51], v[96:99], v[32:35], 0
  s_waitcnt lgkmcnt(2)
  v_mfma_f32_16x16x32_bf16 v[48:51], v[100:103], v[36:39], v[48:51]
  s_waitcnt lgkmcnt(0)
  s_cmp_ge_u32 s3, 2
  s_cbranch_scc1 3f
  v_mfma_f32_16x16x32_bf16 v[48:51], v[104:107], v[40:43], v[48:51]
3:
  v_mov_b32 v13, 158336
  v_mov_b32 v16, 1
  s_nop 6
  ds_write_b128 v55, v[48:51]
  s_waitcnt lgkmcnt(0)
  s_barrier
  s_cmp_lg_u32 s3, 0
  s_cbranch_scc1 L_fb_next
  v_add_u32 v13, 149504, v12
  ds_read_b128 v[96:99], v13 offset:0
  ds_read_b128 v[100:103], v13 offset:1024
  ds_read_b128 v[104:107], v13 offset:2048
  ds_read_b128 v[108:111], v13 offset:3072
  ds_read_b128 v[112:115], v13 offset:4096
  ds_read_b128 v[116:119], v13 offset:5120
  ds_read_b128 v[120:123], v13 offset:6144
  ds_read_b128 v[124:127], v13 offset:7168
  s_lshl_b32 s57, s52, 14
  s_lshl_b32 s58, s46, 6
  s_add_u32 s57, s57, s58
  v_lshlrev_b32 v13, 10, v2
  v_lshl_add_u32 v13, v3, 4, v13
  s_add_u32 s58, s45, s83
  v_mov_b32 v17, s44
  v_mov_b32 v19, s58
  s_waitcnt lgkmcnt(6)
  v_add_f32 v96, v96, v100
  v_add_f32 v97, v97, v101
  v_add_f32 v98, v98, v102
  v_add_f32 v99, v99, v103
  s_waitcnt lgkmcnt(4)
  v_add_f32 v104, v104, v108
  v_add_f32 v105, v105, v109
  v_add_f32 v106, v106, v110
  v_add_f32 v107, v107, v111
  s_waitcnt lgkmcnt(2)
  v_add_f32 v112, v112, v116
  v_add_f32 v113, v113, v117
  v_add_f32 v114, v114, v118
  v_add_f32 v115, v115, v119
  v_add_f32 v96, v96, v104
  v_add_f32 v97, v97, v105
  v_add_f32 v98, v98, v106
  v_add_f32 v99, v99, v107
  s_waitcnt lgkmcnt(0)
  v_add_f32 v120, v120, v124
  v_add_f32 v121, v121, v125
  v_add_f32 v122, v122, v126
  v_add_f32 v123, v123, v127
  v_add_f32 v112, v112, v120
  v_add_f32 v113, v113, v121
  v_add_f32 v114, v114, v122
  v_add_f32 v115, v115, v123
  v_add_f32 v96, v96, v112
  v_add_f32 v97, v97, v113
  v_add_f32 v98, v98, v114
  v_add_f32 v99, v99, v115
  v_cvt_pk_bf16_f32 v16, v96, v97
  v_cvt_pk_bf16_f32 v18, v98, v99
  buffer_store_dwordx4 v[16:19], v13, s[40:43], s57 offen
  s_waitcnt vmcnt(0)
L_fb_next:
  s_barrier
  s_add_u32 s46, s46, 1
  s_cmp_lt_u32 s46, 16
  s_cbranch_scc1 L_fb_loop
  s_cmp_lg_u32 s3, 1
  s_cbranch_scc1 L_fb_done
  s_lshl_b32 s57, s52, 14
  s_lshl_b32 s58, s53, 10
  s_add_u32 s57, s57, s58
  buffer_load_dwordx4 v[16:19], v12, s[40:43], s57 offen sc1
  s_waitcnt vmcnt(0)
  v_mov_b32 v17, v18
  v_lshlrev_b32 v13, 3, v1
  v_add_u32 v13, 157696, v13
  ds_write_b64 v13, v[16:17]
L_fb_done:
  s_waitcnt lgkmcnt(0)
  s_mov_b32 s78, 1
  s_barrier
  ds_read_b128 v[16:19], v14 offset:0
  ds_read_b128 v[20:23], v14 offset:64
  ds_read_b128 v[24:27], v14 offset:128
  ds_read_b128 v[28:31], v14 offset:192
  s_branch L_qk
L_fin:
L_end:
  s_endpgm
.section .rodata,"a"
.p2align 6
.amdhsa_kernel standalone__sliding_block_cached__sampling_kernel
  .amdhsa_next_free_vgpr 256
  .amdhsa_next_free_sgpr 102
  .amdhsa_accum_offset 256
  .amdhsa_group_segment_fixed_size 0
  .amdhsa_kernarg_size 64
  .amdhsa_user_sgpr_count 2
  .amdhsa_user_sgpr_kernarg_segment_ptr 1
  .amdhsa_system_sgpr_workgroup_id_x 1
  .amdhsa_float_denorm_mode_32 3
.end_amdhsa_kernel
```
